```python
import torch

def _softmax(x, axis=-1):
    return torch.softmax(x, dim=axis)
def _gelu(x):
    return torch.nn.functional.gelu(x, approximate="tanh")
def _silu(x):
    return torch.nn.functional.silu(x)
def _sigmoid(x):
    return torch.sigmoid(x)
def _layernorm(x, axis=-1, eps=1e-5):
    m = x.mean(dim=axis, keepdim=True)
    v = x.var(dim=axis, keepdim=True, unbiased=False)
    return (x - m) / torch.sqrt(v + eps)
def _scatter_add(tgt, idx, src, axis=0):
    return tgt.clone().index_add_(axis, idx, src)
def _segment_sum(src, seg, n):
    out = torch.zeros((n,) + src.shape[1:], dtype=src.dtype)
    return out.index_add_(0, seg, src)
def _pad(x, pw):
    flat = tuple(v for pair in reversed(pw) for v in pair)
    return torch.nn.functional.pad(x, flat)

kernel_name = 'parallel_sum__sliding_block__mixer_channel_mlp__prompt'

def setup_inputs():

    _w = (lambda a: (lambda t: t.to(torch.bfloat16) if t.is_floating_point() else t)(torch.as_tensor(a)))
    def _A_setup():
        B, S, D = 1, 2048, 640
        return {
            "x": _w((lambda *s: torch.randn(*s, dtype=torch.bfloat16) * 0.05)(B, S, D)),
            "wqkv": _w((lambda *s: torch.randn(*s, dtype=torch.bfloat16) * 0.05)(D, 3 * D)),
            "wo": _w((lambda *s: torch.randn(*s, dtype=torch.bfloat16) * 0.05)(D, D)),
        }
    _A_in = _A_setup()

    def _B_setup():
        B, S, D, F = 1, 2048, 640, 1728
        return {
            "x": _w((lambda *s: torch.randn(*s, dtype=torch.bfloat16) * 0.05)(B, S, D)),
            "w1": _w((lambda *s: torch.randn(*s, dtype=torch.bfloat16) * 3.2)(D, F) * (D ** -0.5)),
            "b1": _w((lambda *s: torch.randn(*s, dtype=torch.bfloat16) * 1.6)(F)),
            "w2": _w((lambda *s: torch.randn(*s, dtype=torch.bfloat16) * 0.2)(F, D) * (F ** -0.5)),
            "b2": _w((lambda *s: torch.randn(*s, dtype=torch.bfloat16) * 0.4)(D)),
        }
    _B_in = _B_setup()

    return {
        "A_x": _A_in["x"],
        "A_wqkv": _A_in["wqkv"],
        "A_wo": _A_in["wo"],
        "B_x": _B_in["x"],
        "B_w1": _B_in["w1"],
        "B_b1": _B_in["b1"],
        "B_w2": _B_in["w2"],
        "B_b2": _B_in["b2"],
    }

def reference(A_x, A_wqkv, A_wo, B_x, B_w1, B_b1, B_w2, B_b2):
    def _A_ref(x, wqkv, wo):
        B, S, D = x.shape
        H = 32; Dh = D // H; W = 256
        qkv = (lambda x, *d: x.permute(*d))((x @ wqkv).reshape(B, S, 3, H, Dh), 2, 0, 3, 1, 4)
        q, k, v = qkv[0], qkv[1], qkv[2]
        scores = torch.einsum("bhqd,bhkd->bhqk", q, k) * (Dh ** -0.5)
        idx = torch.arange(S)
        mask = (idx[:, None] - idx[None, :] >= 0) & (idx[:, None] - idx[None, :] < W)
        scores = torch.where(mask[None, None], scores, -1e9)
        p = _softmax(scores, axis=-1)
        o = torch.einsum("bhqk,bhkd->bhqd", p, v)
        return (lambda x, *d: x.permute(*d))(o, 0, 2, 1, 3).reshape(B, S, D) @ wo

    def _B_ref(x, w1, b1, w2, b2):
        y = _layernorm(x, axis=-1)
        h = _gelu(torch.einsum("bsd,df->bsf", y, w1) + b1)
        return torch.einsum("bsf,fd->bsd", h, w2) + b2

    x = A_x
    xn = _layernorm(x, axis=-1)
    return x + _A_ref(xn, A_wqkv, A_wo) + _B_ref(xn, B_w1, B_b1, B_w2, B_b2)
```

```asm
; @launch grid=(256,1,1) block=(256,1,1) lds=163840
.amdgcn_target "amdgcn-amd-amdhsa--gfx950"
.text
.globl parallel_sum__sliding_block__mixer_channel_mlp__prompt_kernel
.p2align 8
.type parallel_sum__sliding_block__mixer_channel_mlp__prompt_kernel,@function
parallel_sum__sliding_block__mixer_channel_mlp__prompt_kernel:
  s_cmp_ge_u32 s2, 256
  s_cbranch_scc1 L_end
  s_getpc_b64 s[4:5]
  s_load_dwordx2 s[8:9], s[0:1], 0
  s_load_dwordx2 s[12:13], s[0:1], 8
  s_load_dwordx4 s[40:43], s[0:1], 16
  s_load_dwordx8 s[44:51], s[0:1], 32
  s_load_dwordx4 s[52:55], s[0:1], 64
  s_load_dwordx2 s[56:57], s[0:1], 80
  s_memrealtime s[6:7]
  s_lshr_b32 s66, s2, 3
  s_min_u32 s69, s66, 7
  s_lshl_b32 s69, s69, 12
  v_lshl_add_u32 v2, v0, 4, s69
  v_lshrrev_b32 v1, 6, v0
  global_load_dwordx4 v[4:7], v2, s[4:5]
  v_readfirstlane_b32 s3, v1
  s_and_b32 s67, s66, 7
  s_lshr_b32 s68, s66, 3
  s_and_b32 s58, s2, 4
  s_lshl_b32 s58, s58, 1
  s_add_u32 s58, s58, s67
  s_lshl_b32 s73, s68, 1
  s_add_u32 s73, s73, s67
  s_mul_i32 s73, s73, 5
  s_lshr_b32 s73, s73, 2
  s_cmp_ge_u32 s73, 10
  s_cselect_b32 s69, 10, 0
  s_sub_u32 s73, s73, s69
  v_bfe_u32 v172, v0, 3, 3
  v_and_b32 v173, 7, v0
  v_bfe_u32 v174, v0, 4, 2
  v_mul_u32_u24 v172, 1280, v172
  v_xor_b32_e64 v173, v173, v174
  s_lshl_b32 s37, s58, 2
  s_add_u32 s37, s37, s3
  s_mul_i32 s37, s37, 40960
  s_lshl_b32 s62, s73, 7
  s_add_u32 s62, s62, s37
  v_lshl_add_u32 v124, v173, 4, v172
  s_lshl_b32 s88, s3, 12
  v_xor_b32 v125, 64, v124
  s_mov_b32 m0, s88
  v_add_u32 v125, 9216, v125
  s_mov_b32 s10, 2621440
  s_mov_b32 s11, 0x20000
  v_add_u32 v126, 18432, v124
  v_add_u32 v127, 18432, v125
  s_waitcnt lgkmcnt(0)
  buffer_load_dwordx4 v124, s[8:11], s62 offen offset:0 lds
  buffer_load_dwordx4 v125, s[8:11], s62 offen offset:1024 lds
  buffer_load_dwordx4 v126, s[8:11], s62 offen offset:2048 lds
  buffer_load_dwordx4 v127, s[8:11], s62 offen offset:3072 lds
  s_and_b32 s59, s2, 3
  s_lshl_b32 s59, s59, 2
  s_add_u32 s59, s59, s68
  v_lshlrev_b32 v172, 2, v174
  v_and_b32_e64 v173, 15, v0
  v_mul_u32_u24 v174, 3840, v174
  v_xor_b32_e64 v173, v173, v172
  s_min_u32 s38, s59, 14
  s_lshl_b32 s38, s38, 8
  s_mul_i32 s69, s3, 61440
  s_add_u32 s38, s38, s69
  s_mul_i32 s63, s73, 245760
  s_add_u32 s63, s63, s38
  v_lshl_add_u32 v128, v173, 4, v174
  s_add_u32 s89, s88, 16384
  s_mov_b32 m0, s89
  s_cmp_lt_u32 s59, 15
  s_cselect_b32 s14, 2457600, 0
  s_mov_b32 s15, 0x20000
  v_add_u32 v129, 14336, v128
  v_add_u32 v130, 28672, v128
  v_add_u32 v131, 43008, v128
  buffer_load_dwordx4 v128, s[12:15], s63 offen offset:0 lds
  buffer_load_dwordx4 v129, s[12:15], s63 offen offset:1024 lds
  buffer_load_dwordx4 v130, s[12:15], s63 offen offset:2048 lds
  buffer_load_dwordx4 v131, s[12:15], s63 offen offset:3072 lds
  s_mov_b32 s32, s54
  s_mov_b32 s33, s55
  s_mov_b32 s34, 256
  s_mov_b32 s35, 0x20000
  s_or_b32 s65, s2, s3
  v_mov_b32 v188, 0
  s_cmp_lg_u32 s65, 0
  s_cbranch_scc1 Lskip_1
  s_or_b32 s6, s6, 1
  v_mov_b32 v189, s6
  buffer_store_dword v189, v188, s[32:35], 0 offen sc1
Lskip_1:
  v_and_b32_e64 v190, 63, v0
  s_add_u32 s36, s37, 1280
  s_add_u32 s62, s62, 128
  s_add_u32 s63, s63, 245760
  s_cmp_eq_u32 s62, s36
  s_cselect_b32 s62, s37, s62
  s_cselect_b32 s63, s38, s63
  s_and_b32 s65, s2, 7
  s_lshl_b32 s84, s65, 2
  s_add_u32 s84, s84, s68
  s_mov_b32 s85, s67
  s_and_b32 s60, s3, 1
  s_lshr_b32 s61, s3, 1
  s_lshr_b32 s86, s65, 1
  s_lshl_b32 s86, s86, 3
  s_add_u32 s86, s86, s67
  s_and_b32 s87, s65, 1
  s_lshl_b32 s87, s87, 2
  s_add_u32 s87, s87, s68
  s_mov_b32 s16, s44
  s_mov_b32 s17, s45
  s_mov_b32 s18, 2211840
  s_mov_b32 s19, 0x20000
  s_mov_b32 s20, s56
  s_mov_b32 s21, s57
  s_mov_b32 s22, 24117248
  s_mov_b32 s23, 0x20000
  s_sub_u32 s74, s59, 2
  s_lshl_b32 s74, s74, 1
  s_cmp_lt_u32 s59, 2
  s_cselect_b32 s74, 100, s74
  s_add_u32 s75, s74, 1
  s_cmp_lt_u32 s59, 5
  s_cselect_b32 s76, 0x3ea52b5c, 1.0
  s_min_u32 s83, s74, 26
  s_lshl_b32 s83, s83, 7
  s_min_u32 s93, s75, 26
  s_lshl_b32 s93, s93, 7
  s_mul_i32 s64, s73, 221184
  s_add_u32 s64, s64, s83
  s_add_u32 s82, s83, 2211840
  s_lshl_b32 s92, s3, 11
  s_cmp_lt_u32 s74, 27
  s_cselect_b32 s18, s18, 0
  s_lshl_b32 s66, s3, 4
  v_lshrrev_b32 v174, 3, v190
  v_add_u32_e64 v172, s66, v174
  v_mul_u32_u24 v172, 3456, v172
  v_and_b32_e64 v173, 7, v190
  v_bfe_u32 v174, v190, 4, 1
  v_lshlrev_b32 v174, 2, v174
  v_xor_b32 v173, v173, v174
  v_lshl_add_u32 v132, v173, 4, v172
  v_add_u32 v133, 26624, v132
  v_and_b32_e64 v172, 31, v190
  v_bfe_u32 v173, v190, 1, 3
  v_lshrrev_b32 v174, 5, v190
  v_xor_b32 v173, v173, v174
  s_lshl_b32 s65, s60, 1
  v_xor_b32 v173, s65, v173
  s_lshl_b32 s65, s60, 13
  v_lshlrev_b32 v172, 7, v172
  v_add_u32 v172, s65, v172
  v_xor_b32 v174, 0, v173
  v_lshl_add_u32 v134, v174, 4, v172
  v_xor_b32_e64 v174, 2, v173
  v_lshl_add_u32 v135, v174, 4, v172
  v_xor_b32_e64 v174, 4, v173
  v_lshl_add_u32 v136, v174, 4, v172
  v_xor_b32_e64 v174, 6, v173
  v_lshl_add_u32 v137, v174, 4, v172
  v_bfe_u32 v172, v190, 4, 1
  v_and_b32_e64 v173, 1, v190
  v_lshl_add_u32 v175, v172, 1, v173
  v_lshrrev_b32_e64 v172, 5, v190
  v_bfe_u32 v173, v190, 2, 2
  v_lshl_add_u32 v176, v172, 3, v173
  v_bfe_u32 v174, v190, 1, 1
  v_lshlrev_b32 v174, 3, v174
  s_lshl_b32 s65, s61, 3
  v_add_u32 v172, s65, v175
  v_lshlrev_b32 v177, 2, v173
  v_xor_b32_e64 v172, v172, v177
  v_lshl_add_u32 v172, v172, 4, v174
  v_lshl_add_u32 v172, v176, 8, v172
  v_add_u32 v172, 16384, v172
  s_lshl_b32 s66, s60, 12
  v_add_u32 v138, s66, v172
  s_xor_b32 s66, s66, 4096
  v_add_u32 v139, s66, v172
  v_xor_b32 v140, 64, v138
  v_xor_b32 v141, 64, v139
  s_lshl_b32 s65, s61, 2
  v_add_u32 v172, s65, v175
  v_lshrrev_b32 v177, 1, v173
  v_lshlrev_b32 v177, 2, v177
  v_xor_b32 v172, v172, v177
  v_lshl_add_u32 v172, v172, 4, v174
  v_lshl_add_u32 v172, v176, 7, v172
  s_lshl_b32 s66, s60, 11
  v_add_u32 v142, s66, v172
  s_xor_b32 s66, s66, 2048
  v_add_u32 v143, s66, v172
  v_and_b32 v172, 31, v190
  v_cmp_eq_u32_e64 vcc, 0, v172
  v_cmp_eq_u32 s[78:79], 20, v172
  v_mov_b32 v173, 0x3f803f80
  s_or_b64 vcc, vcc, s[78:79]
  v_cndmask_b32 v120, 0, v173, vcc
  v_mov_b32 v121, v120
  v_mov_b32 v122, v120
  v_mov_b32 v123, v120
  v_lshrrev_b32 v173, 5, v190
  v_lshlrev_b32_e64 v173, 15, v173
  v_lshl_add_u32 v170, v172, 4, v173
  v_lshlrev_b32 v171, 4, v190
  s_mul_i32 s65, s2, 3
  s_add_u32 s65, s65, s3
  s_add_u32 s66, s2, 768
  s_cmp_eq_u32 s3, 3
  s_cselect_b32 s99, s66, s65
  s_mul_i32 s80, s99, 6554
  s_lshr_b32 s80, s80, 16
  s_mul_i32 s67, s80, 10
  s_sub_u32 s81, s99, s67
  s_lshl_b32 s39, s80, 5
  s_cmp_lt_u32 s80, 54
  s_cselect_b32 s28, s48, s40
  s_cselect_b32 s29, s49, s41
  s_mov_b32 s30, 819200
  s_cselect_b32 s30, 2211840, s30
  s_mov_b32 s31, 0x20000
  s_mov_b32 s42, 8
  s_mov_b32 s43, 16
  s_mov_b32 s71, 4
  s_cbranch_scc1 Lskip_2
  s_sub_u32 s39, s80, 54
  s_mul_i32 s39, s39, 40
  s_mov_b32 s42, 4
  s_mov_b32 s43, 20
  s_mov_b32 s71, 8
  s_cmp_lt_u32 s80, 70
  s_cbranch_scc1 Lskip_3
  s_sub_u32 s39, s80, 70
  s_mul_i32 s39, s39, 160
  s_add_u32 s39, s39, 16
  s_mov_b32 s42, 40
  s_mov_b32 s43, 80
  s_mov_b32 s71, 20
  s_cmp_lt_u32 s80, 74
  s_cselect_b32 s30, s30, 0
  s_cselect_b32 s39, s39, 0
Lskip_3:
Lskip_2:
  v_lshrrev_b32 v160, 5, v190
  v_mul_u32_u24_e64 v160, s71, v160
  v_bfe_u32 v173, v190, 3, 2
  v_add_u32_e64 v160, v160, v173
  v_mul_u32_u24 v160, 1280, v160
  v_and_b32_e64 v173, 7, v190
  v_lshl_add_u32 v160, v173, 4, v160
  s_lshl_b32 s72, s81, 7
  v_add_u32 v160, s72, v160
  s_mul_i32 s39, s39, 1280
  s_mul_i32 s42, s42, 1280
  s_mul_i32 s43, s43, 1280
  s_lshl_b32 s65, s58, 7
  s_lshl_b32 s66, s59, 3
  s_add_u32 s65, s65, s66
  s_lshl_b32 s66, s3, 1
  s_add_u32 s98, s65, s66
  v_lshrrev_b32 v154, 5, v190
  v_add_u32_e64 v154, s98, v154
  v_mul_u32_u24 v155, 1280, v154
  v_and_b32_e64 v156, 31, v190
  v_lshl_add_u32 v154, v156, 3, v155
  v_lshl_add_u32 v155, v156, 4, v155
  buffer_load_dwordx4 v[144:147], v155, s[8:11], 0 offen
  buffer_load_dwordx4 v[148:151], v155, s[8:11], 0 offen offset:512
  buffer_load_dwordx2 v[152:153], v154, s[8:11], 0 offen offset:1024
  v_and_b32_e64 v177, 0x13, v190
  v_bfe_u32 v168, v190, 2, 1
  v_lshl_or_b32 v177, v168, 3, v177
  v_bfe_u32 v168, v190, 3, 1
  v_lshl_or_b32 v177, v168, 2, v177
  v_lshlrev_b32 v177, 1, v177
  v_lshrrev_b32 v168, 5, v190
  v_lshl_or_b32 v177, v168, 16, v177
  s_lshl_b32 s72, s61, 6
  v_add_u32 v177, s72, v177
  s_mov_b32 s24, s46
  s_mov_b32 s25, s47
  s_mov_b32 s26, 3456
  s_mov_b32 s27, 0x20000
  v_add_u32_e64 v168, s83, v177
  v_add_u32 v169, s93, v177
  s_add_u32 m0, s88, 32768
  s_nop 0
  buffer_load_dwordx4 v124, s[8:11], s62 offen offset:0 lds
  buffer_load_dwordx4 v125, s[8:11], s62 offen offset:1024 lds
  buffer_load_dwordx4 v126, s[8:11], s62 offen offset:2048 lds
  buffer_load_dwordx4 v127, s[8:11], s62 offen offset:3072 lds
  s_add_u32 m0, s89, 32768
  s_add_u32 s62, s62, 128
  buffer_load_dwordx4 v128, s[12:15], s63 offen offset:0 lds
  buffer_load_dwordx4 v129, s[12:15], s63 offen offset:1024 lds
  buffer_load_dwordx4 v130, s[12:15], s63 offen offset:2048 lds
  buffer_load_dwordx4 v131, s[12:15], s63 offen offset:3072 lds
  s_add_u32 s63, s63, 245760
  s_cmp_eq_u32 s62, s36
  s_cselect_b32 s62, s37, s62
  s_cselect_b32 s63, s38, s63
  s_waitcnt vmcnt(11)
  s_barrier
  ds_read_b128 a[0:3], v134 offset:0
  ds_read_b128 a[4:7], v134 offset:4096
  ds_read_b64_tr_b16 v[96:97], v138 offset:0
  ds_read_b64_tr_b16 v[98:99], v138 offset:1024
  ds_read_b64_tr_b16 v[100:101], v140 offset:0
  ds_read_b64_tr_b16 v[102:103], v140 offset:1024
  s_waitcnt lgkmcnt(2)
  v_mfma_f32_32x32x16_bf16 v[0:15], v[96:99], a[0:3], 0
  ds_read_b64_tr_b16 v[104:105], v139 offset:0
  ds_read_b64_tr_b16 v[106:107], v139 offset:1024
  ds_read_b64_tr_b16 v[108:109], v141 offset:0
  ds_read_b64_tr_b16 v[110:111], v141 offset:1024
  s_waitcnt vmcnt(10)
  v_lshlrev_b32 v64, 16, v144
  v_and_b32 v65, 0xffff0000, v144
  v_mfma_f32_32x32x16_bf16 v[16:31], v[96:99], a[4:7], 0
  ds_read_b128 a[8:11], v135 offset:0
  ds_read_b128 a[12:15], v135 offset:4096
  s_add_u32 m0, s88, 65536
  s_nop 0
  buffer_load_dwordx4 v124, s[8:11], s62 offen offset:0 lds
  s_waitcnt lgkmcnt(6)
  v_mfma_f32_32x32x16_bf16 v[32:47], v[100:103], a[0:3], 0
  buffer_load_dwordx4 v125, s[8:11], s62 offen offset:1024 lds
  v_lshlrev_b32_e64 v66, 16, v145
  v_and_b32 v67, 0xffff0000, v145
  v_lshlrev_b32_e64 v68, 16, v146
  v_and_b32 v69, 0xffff0000, v146
  v_lshlrev_b32_e64 v70, 16, v147
  v_mfma_f32_16x16x32_bf16 v[112:115], v[120:123], v[96:99], 0
  v_and_b32 v71, 0xffff0000, v147
  s_waitcnt vmcnt(11)
  v_lshlrev_b32 v72, 16, v148
  v_mfma_f32_32x32x16_bf16 v[48:63], v[100:103], a[4:7], 0
  buffer_load_dwordx4 v126, s[8:11], s62 offen offset:2048 lds
  v_and_b32 v73, 0xffff0000, v148
  v_lshlrev_b32_e64 v74, 16, v149
  v_and_b32 v75, 0xffff0000, v149
  v_lshlrev_b32_e64 v76, 16, v150
  v_and_b32 v77, 0xffff0000, v150
  v_mfma_f32_16x16x32_bf16 v[116:119], v[120:123], v[100:103], 0
  v_lshlrev_b32_e64 v78, 16, v151
  s_waitcnt lgkmcnt(1)
  v_mfma_f32_32x32x16_bf16 v[0:15], v[104:107], a[8:11], v[0:15]
  ds_read_b64_tr_b16 v[96:97], v138 offset:8192
  ds_read_b64_tr_b16 v[98:99], v138 offset:9216
  ds_read_b64_tr_b16 v[100:101], v140 offset:8192
  ds_read_b64_tr_b16 v[102:103], v140 offset:9216
  v_and_b32 v79, 0xffff0000, v151
  s_waitcnt lgkmcnt(4)
  v_mfma_f32_32x32x16_bf16 v[16:31], v[104:107], a[12:15], v[16:31]
  ds_read_b128 a[16:19], v136 offset:0
  ds_read_b128 a[20:23], v136 offset:4096
  buffer_load_dwordx4 v127, s[8:11], s62 offen offset:3072 lds
  s_add_u32 m0, s89, 65536
  s_add_u32 s62, s62, 128
  v_mfma_f32_32x32x16_bf16 v[32:47], v[108:111], a[8:11], v[32:47]
  buffer_load_dwordx4 v128, s[12:15], s63 offen offset:0 lds
  v_mfma_f32_32x32x16_bf16 v[48:63], v[108:111], a[12:15], v[48:63]
  buffer_load_dwordx4 v129, s[12:15], s63 offen offset:1024 lds
  s_waitcnt lgkmcnt(1)
  v_mfma_f32_32x32x16_bf16 v[0:15], v[96:99], a[16:19], v[0:15]
  ds_read_b64_tr_b16 v[104:105], v139 offset:8192
  ds_read_b64_tr_b16 v[106:107], v139 offset:9216
  ds_read_b64_tr_b16 v[108:109], v141 offset:8192
  ds_read_b64_tr_b16 v[110:111], v141 offset:9216
  s_waitcnt vmcnt(14)
  v_lshlrev_b32 v80, 16, v152
  s_waitcnt lgkmcnt(4)
  v_mfma_f32_32x32x16_bf16 v[16:31], v[96:99], a[20:23], v[16:31]
  ds_read_b128 a[24:27], v137 offset:0
  ds_read_b128 a[28:31], v137 offset:4096
  buffer_load_dwordx4 v130, s[12:15], s63 offen offset:2048 lds
  v_mfma_f32_32x32x16_bf16 v[32:47], v[100:103], a[16:19], v[32:47]
  buffer_load_dwordx4 v131, s[12:15], s63 offen offset:3072 lds
  s_add_u32 s63, s63, 245760
  s_cmp_eq_u32 s62, s36
  s_cselect_b32 s62, s37, s62
  s_cselect_b32 s63, s38, s63
  v_mfma_f32_16x16x32_bf16 v[112:115], v[120:123], v[96:99], v[112:115]
  v_and_b32 v81, 0xffff0000, v152
  v_lshlrev_b32_e64 v82, 16, v153
  v_mfma_f32_32x32x16_bf16 v[48:63], v[100:103], a[20:23], v[48:63]
  s_add_u32 m0, s88, 131072
  s_mov_b32 s7, s39
  buffer_load_dwordx4 v160, s[28:31], s7 offen nt lds
  v_mfma_f32_16x16x32_bf16 v[116:119], v[120:123], v[100:103], v[116:119]
  v_and_b32 v83, 0xffff0000, v153
  s_waitcnt lgkmcnt(1)
  v_mfma_f32_32x32x16_bf16 v[0:15], v[104:107], a[24:27], v[0:15]
  s_waitcnt lgkmcnt(0)
  s_waitcnt vmcnt(9)
  s_barrier
  ds_read_b64_tr_b16 v[96:97], v138 offset:32768
  ds_read_b64_tr_b16 v[98:99], v138 offset:33792
  ds_read_b64_tr_b16 v[100:101], v140 offset:32768
  ds_read_b64_tr_b16 v[102:103], v140 offset:33792
  v_mfma_f32_32x32x16_bf16 v[16:31], v[104:107], a[28:31], v[16:31]
  ds_read_b128 a[32:35], v134 offset:32768
  ds_read_b128 a[36:39], v134 offset:36864
  s_add_u32 m0, s88, 132096
  s_add_u32 s7, s39, s42
  buffer_load_dwordx4 v160, s[28:31], s7 offen nt lds
  v_mfma_f32_32x32x16_bf16 v[32:47], v[108:111], a[24:27], v[32:47]
  s_add_u32 m0, s88, 133120
  s_add_u32 s7, s39, s43
  buffer_load_dwordx4 v160, s[28:31], s7 offen nt lds
  v_mfma_f32_32x32x16_bf16 v[48:63], v[108:111], a[28:31], v[48:63]
  s_add_u32 m0, s88, 134144
  s_add_u32 s7, s7, s42
  buffer_load_dwordx4 v160, s[28:31], s7 offen nt lds
  s_waitcnt lgkmcnt(1)
  v_mfma_f32_32x32x16_bf16 v[0:15], v[96:99], a[32:35], v[0:15]
  ds_read_b64_tr_b16 v[104:105], v139 offset:32768
  ds_read_b64_tr_b16 v[106:107], v139 offset:33792
  ds_read_b64_tr_b16 v[108:109], v141 offset:32768
  ds_read_b64_tr_b16 v[110:111], v141 offset:33792
  v_add_f32 v158, v64, v65
  s_waitcnt lgkmcnt(4)
  v_mfma_f32_32x32x16_bf16 v[16:31], v[96:99], a[36:39], v[16:31]
  ds_read_b128 a[40:43], v135 offset:32768
  ds_read_b128 a[44:47], v135 offset:36864
  buffer_load_ushort v168, v168, s[24:27], 0 offen
  buffer_load_ushort v169, v169, s[24:27], 0 offen
  s_mov_b32 s24, s52
  s_mov_b32 s25, s53
  s_mov_b32 s26, 2621440
  s_mov_b32 s27, 0x20000
  buffer_load_dword v189, v188, s[32:35], 0 offen sc1
  v_mfma_f32_32x32x16_bf16 v[32:47], v[100:103], a[32:35], v[32:47]
  s_add_u32 m0, s88, 98304
  s_nop 0
  buffer_load_dwordx4 v124, s[8:11], s62 offen offset:0 lds
  v_mfma_f32_16x16x32_bf16 v[112:115], v[120:123], v[96:99], v[112:115]
  v_add_f32 v154, v66, v67
  v_add_f32_e64 v158, v158, v68
  v_mfma_f32_32x32x16_bf16 v[48:63], v[100:103], a[36:39], v[48:63]
  buffer_load_dwordx4 v125, s[8:11], s62 offen offset:1024 lds
  v_mfma_f32_16x16x32_bf16 v[116:119], v[120:123], v[100:103], v[116:119]
  v_add_f32 v154, v154, v69
  s_waitcnt lgkmcnt(1)
  v_mfma_f32_32x32x16_bf16 v[0:15], v[104:107], a[40:43], v[0:15]
  ds_read_b64_tr_b16 v[96:97], v138 offset:40960
  ds_read_b64_tr_b16 v[98:99], v138 offset:41984
  ds_read_b64_tr_b16 v[100:101], v140 offset:40960
  ds_read_b64_tr_b16 v[102:103], v140 offset:41984
  v_add_f32 v158, v158, v70
  s_waitcnt lgkmcnt(4)
  v_mfma_f32_32x32x16_bf16 v[16:31], v[104:107], a[44:47], v[16:31]
  ds_read_b128 a[48:51], v136 offset:32768
  ds_read_b128 a[52:55], v136 offset:36864
  buffer_load_dwordx4 v126, s[8:11], s62 offen offset:2048 lds
  v_add_f32 v154, v154, v71
  v_mfma_f32_32x32x16_bf16 v[32:47], v[108:111], a[40:43], v[32:47]
  buffer_load_dwordx4 v127, s[8:11], s62 offen offset:3072 lds
  s_add_u32 m0, s89, 98304
  s_add_u32 s62, s62, 128
  v_mfma_f32_32x32x16_bf16 v[48:63], v[108:111], a[44:47], v[48:63]
  buffer_load_dwordx4 v128, s[12:15], s63 offen offset:0 lds
  s_waitcnt lgkmcnt(1)
  v_mfma_f32_32x32x16_bf16 v[0:15], v[96:99], a[48:51], v[0:15]
  ds_read_b64_tr_b16 v[104:105], v139 offset:40960
  ds_read_b64_tr_b16 v[106:107], v139 offset:41984
  ds_read_b64_tr_b16 v[108:109], v141 offset:40960
  ds_read_b64_tr_b16 v[110:111], v141 offset:41984
  v_add_f32 v158, v158, v72
  s_waitcnt lgkmcnt(4)
  v_mfma_f32_32x32x16_bf16 v[16:31], v[96:99], a[52:55], v[16:31]
  ds_read_b128 a[56:59], v137 offset:32768
  ds_read_b128 a[60:63], v137 offset:36864
  buffer_load_dwordx4 v129, s[12:15], s63 offen offset:1024 lds
  v_mfma_f32_32x32x16_bf16 v[32:47], v[100:103], a[48:51], v[32:47]
  v_xor_b32 v134, 0x10000, v134
  v_xor_b32 v135, 0x10000, v135
  v_xor_b32 v136, 0x10000, v136
  v_xor_b32 v137, 0x10000, v137
  buffer_load_dwordx4 v130, s[12:15], s63 offen offset:2048 lds
  v_mfma_f32_16x16x32_bf16 v[112:115], v[120:123], v[96:99], v[112:115]
  v_add_f32 v154, v154, v73
  v_add_f32 v158, v158, v74
  v_mfma_f32_32x32x16_bf16 v[48:63], v[100:103], a[52:55], v[48:63]
  v_xor_b32 v138, 0x10000, v138
  v_xor_b32 v139, 0x10000, v139
  v_xor_b32 v140, 0x10000, v140
  v_xor_b32 v141, 0x10000, v141
  buffer_load_dwordx4 v131, s[12:15], s63 offen offset:3072 lds
  s_add_u32 s63, s63, 245760
  s_cmp_eq_u32 s62, s36
  s_cselect_b32 s62, s37, s62
  s_cselect_b32 s63, s38, s63
  v_mfma_f32_16x16x32_bf16 v[116:119], v[120:123], v[100:103], v[116:119]
  v_add_f32 v154, v154, v75
  s_waitcnt lgkmcnt(1)
  v_mfma_f32_32x32x16_bf16 v[0:15], v[104:107], a[56:59], v[0:15]
  s_waitcnt lgkmcnt(0)
  s_waitcnt vmcnt(15)
  s_barrier
  ds_read_b64_tr_b16 v[96:97], v138 offset:0
  ds_read_b64_tr_b16 v[98:99], v138 offset:1024
  ds_read_b64_tr_b16 v[100:101], v140 offset:0
  ds_read_b64_tr_b16 v[102:103], v140 offset:1024
  v_mfma_f32_32x32x16_bf16 v[16:31], v[104:107], a[60:63], v[16:31]
  ds_read_b128 a[64:67], v134 offset:0
  ds_read_b128 a[68:71], v134 offset:4096
  s_add_u32 m0, s88, 0
  s_nop 0
  buffer_load_dwordx4 v124, s[8:11], s62 offen offset:0 lds
  v_add_f32 v158, v158, v76
  v_mfma_f32_32x32x16_bf16 v[32:47], v[108:111], a[56:59], v[32:47]
  buffer_load_dwordx4 v125, s[8:11], s62 offen offset:1024 lds
  v_mfma_f32_32x32x16_bf16 v[48:63], v[108:111], a[60:63], v[48:63]
  buffer_load_dwordx4 v126, s[8:11], s62 offen offset:2048 lds
  s_waitcnt lgkmcnt(1)
  v_mfma_f32_32x32x16_bf16 v[0:15], v[96:99], a[64:67], v[0:15]
  ds_read_b64_tr_b16 v[104:105], v139 offset:0
  ds_read_b64_tr_b16 v[106:107], v139 offset:1024
  ds_read_b64_tr_b16 v[108:109], v141 offset:0
  ds_read_b64_tr_b16 v[110:111], v141 offset:1024
  v_add_f32 v154, v154, v77
  s_waitcnt lgkmcnt(4)
  v_mfma_f32_32x32x16_bf16 v[16:31], v[96:99], a[68:71], v[16:31]
  ds_read_b128 a[72:75], v135 offset:0
  ds_read_b128 a[76:79], v135 offset:4096
  buffer_load_dwordx4 v127, s[8:11], s62 offen offset:3072 lds
  s_add_u32 m0, s89, 0
  s_add_u32 s62, s62, 128
  v_mfma_f32_32x32x16_bf16 v[32:47], v[100:103], a[64:67], v[32:47]
  buffer_load_dwordx4 v128, s[12:15], s63 offen offset:0 lds
  v_mfma_f32_16x16x32_bf16 v[112:115], v[120:123], v[96:99], v[112:115]
  v_add_f32 v158, v158, v78
  v_add_f32_e64 v154, v154, v79
  v_mfma_f32_32x32x16_bf16 v[48:63], v[100:103], a[68:71], v[48:63]
  buffer_load_dwordx4 v129, s[12:15], s63 offen offset:1024 lds
  v_mfma_f32_16x16x32_bf16 v[116:119], v[120:123], v[100:103], v[116:119]
  v_add_f32 v158, v158, v80
  s_waitcnt lgkmcnt(1)
  v_mfma_f32_32x32x16_bf16 v[0:15], v[104:107], a[72:75], v[0:15]
  ds_read_b64_tr_b16 v[96:97], v138 offset:8192
  ds_read_b64_tr_b16 v[98:99], v138 offset:9216
  ds_read_b64_tr_b16 v[100:101], v140 offset:8192
  ds_read_b64_tr_b16 v[102:103], v140 offset:9216
  v_add_f32 v154, v154, v81
  s_waitcnt lgkmcnt(4)
  v_mfma_f32_32x32x16_bf16 v[16:31], v[104:107], a[76:79], v[16:31]
  ds_read_b128 a[80:83], v136 offset:0
  ds_read_b128 a[84:87], v136 offset:4096
  buffer_load_dwordx4 v130, s[12:15], s63 offen offset:2048 lds
  v_add_f32 v158, v158, v82
  v_mfma_f32_32x32x16_bf16 v[32:47], v[108:111], a[72:75], v[32:47]
  buffer_load_dwordx4 v131, s[12:15], s63 offen offset:3072 lds
  s_add_u32 s63, s63, 245760
  s_cmp_eq_u32 s62, s36
  s_cselect_b32 s62, s37, s62
  s_cselect_b32 s63, s38, s63
  v_mfma_f32_32x32x16_bf16 v[48:63], v[108:111], a[76:79], v[48:63]
  s_add_u32 m0, s88, 32768
  s_nop 0
  buffer_load_dwordx4 v124, s[8:11], s62 offen offset:0 lds
  s_waitcnt lgkmcnt(1)
  v_mfma_f32_32x32x16_bf16 v[0:15], v[96:99], a[80:83], v[0:15]
  ds_read_b64_tr_b16 v[104:105], v139 offset:8192
  ds_read_b64_tr_b16 v[106:107], v139 offset:9216
  ds_read_b64_tr_b16 v[108:109], v141 offset:8192
  ds_read_b64_tr_b16 v[110:111], v141 offset:9216
  v_add_f32 v154, v154, v83
  s_waitcnt lgkmcnt(4)
  v_mfma_f32_32x32x16_bf16 v[16:31], v[96:99], a[84:87], v[16:31]
  ds_read_b128 a[88:91], v137 offset:0
  ds_read_b128 a[92:95], v137 offset:4096
  buffer_load_dwordx4 v125, s[8:11], s62 offen offset:1024 lds
  v_mfma_f32_32x32x16_bf16 v[32:47], v[100:103], a[80:83], v[32:47]
  buffer_load_dwordx4 v126, s[8:11], s62 offen offset:2048 lds
  v_mfma_f32_16x16x32_bf16 v[112:115], v[120:123], v[96:99], v[112:115]
  v_add_f32 v158, v158, v154
  s_nop 1
  v_add_f32_dpp v158, v158, v158 row_ror:8 row_mask:0xf bank_mask:0xf
  v_mfma_f32_32x32x16_bf16 v[48:63], v[100:103], a[84:87], v[48:63]
  s_nop 0
  v_add_f32_dpp v158, v158, v158 row_ror:4 row_mask:0xf bank_mask:0xf
  s_nop 1
  v_add_f32_dpp v158, v158, v158 row_ror:2 row_mask:0xf bank_mask:0xf
  s_nop 1
  v_add_f32_dpp v158, v158, v158 row_ror:1 row_mask:0xf bank_mask:0xf
  v_mov_b32 v154, v158
  s_nop 1
  v_permlane16_swap_b32 v158, v154
  v_add_f32_e64 v158, v158, v154
  v_mfma_f32_16x16x32_bf16 v[116:119], v[120:123], v[100:103], v[116:119]
  v_mul_f32 v158, 0xbacccccd, v158
  s_waitcnt lgkmcnt(1)
  v_mfma_f32_32x32x16_bf16 v[0:15], v[104:107], a[88:91], v[0:15]
  s_waitcnt lgkmcnt(0)
  s_waitcnt vmcnt(11)
  s_barrier
  ds_read_b64_tr_b16 v[96:97], v138 offset:32768
  ds_read_b64_tr_b16 v[98:99], v138 offset:33792
  ds_read_b64_tr_b16 v[100:101], v140 offset:32768
  ds_read_b64_tr_b16 v[102:103], v140 offset:33792
  v_mfma_f32_32x32x16_bf16 v[16:31], v[104:107], a[92:95], v[16:31]
  ds_read_b128 a[96:99], v134 offset:32768
  ds_read_b128 a[100:103], v134 offset:36864
  buffer_load_dwordx4 v127, s[8:11], s62 offen offset:3072 lds
  s_add_u32 m0, s89, 32768
  s_add_u32 s62, s62, 128
  v_add_f32_e64 v64, v64, v158
  v_mfma_f32_32x32x16_bf16 v[32:47], v[108:111], a[88:91], v[32:47]
  buffer_load_dwordx4 v128, s[12:15], s63 offen offset:0 lds
  v_add_f32 v65, v65, v158
  v_add_f32 v66, v66, v158
  v_add_f32 v67, v67, v158
  v_add_f32 v68, v68, v158
  v_add_f32_e64 v69, v69, v158
  v_mfma_f32_32x32x16_bf16 v[48:63], v[108:111], a[92:95], v[48:63]
  v_add_f32 v70, v70, v158
  v_add_f32 v71, v71, v158
  v_add_f32 v72, v72, v158
  v_add_f32 v73, v73, v158
  v_add_f32 v74, v74, v158
  s_waitcnt lgkmcnt(1)
  v_mfma_f32_32x32x16_bf16 v[0:15], v[96:99], a[96:99], v[0:15]
  ds_read_b64_tr_b16 v[104:105], v139 offset:32768
  ds_read_b64_tr_b16 v[106:107], v139 offset:33792
  ds_read_b64_tr_b16 v[108:109], v141 offset:32768
  ds_read_b64_tr_b16 v[110:111], v141 offset:33792
  v_add_f32 v75, v75, v158
  s_waitcnt lgkmcnt(4)
  v_mfma_f32_32x32x16_bf16 v[16:31], v[96:99], a[100:103], v[16:31]
  ds_read_b128 a[104:107], v135 offset:32768
  ds_read_b128 a[108:111], v135 offset:36864
  buffer_load_dwordx4 v129, s[12:15], s63 offen offset:1024 lds
  v_add_f32 v76, v76, v158
  v_add_f32 v77, v77, v158
  v_add_f32_e64 v78, v78, v158
  v_mfma_f32_32x32x16_bf16 v[32:47], v[100:103], a[96:99], v[32:47]
  buffer_load_dwordx4 v130, s[12:15], s63 offen offset:2048 lds
  v_add_f32 v79, v79, v158
  v_add_f32 v80, v80, v158
  v_add_f32 v81, v81, v158
  v_add_f32 v82, v82, v158
  v_mfma_f32_16x16x32_bf16 v[112:115], v[120:123], v[96:99], v[112:115]
  v_add_f32 v83, v83, v158
  v_mul_f32 v155, v64, v64
  v_mfma_f32_32x32x16_bf16 v[48:63], v[100:103], a[100:103], v[48:63]
  v_mul_f32 v156, v65, v65
  v_fmac_f32 v155, v66, v66
  v_fmac_f32 v156, v67, v67
  v_fmac_f32 v155, v68, v68
  v_fmac_f32 v156, v69, v69
  v_fmac_f32 v155, v70, v70
  v_mfma_f32_16x16x32_bf16 v[116:119], v[120:123], v[100:103], v[116:119]
  v_fmac_f32 v156, v71, v71
  s_waitcnt lgkmcnt(1)
  v_mfma_f32_32x32x16_bf16 v[0:15], v[104:107], a[104:107], v[0:15]
  ds_read_b64_tr_b16 v[96:97], v138 offset:40960
  ds_read_b64_tr_b16 v[98:99], v138 offset:41984
  ds_read_b64_tr_b16 v[100:101], v140 offset:40960
  ds_read_b64_tr_b16 v[102:103], v140 offset:41984
  v_fmac_f32 v155, v72, v72
  s_waitcnt lgkmcnt(4)
  v_mfma_f32_32x32x16_bf16 v[16:31], v[104:107], a[108:111], v[16:31]
  ds_read_b128 a[112:115], v136 offset:32768
  ds_read_b128 a[116:119], v136 offset:36864
  buffer_load_dwordx4 v131, s[12:15], s63 offen offset:3072 lds
  s_add_u32 s63, s63, 245760
  s_cmp_eq_u32 s62, s36
  s_cselect_b32 s62, s37, s62
  s_cselect_b32 s63, s38, s63
  v_mfma_f32_32x32x16_bf16 v[32:47], v[108:111], a[104:107], v[32:47]
  s_add_u32 m0, s88, 65536
  s_nop 0
  buffer_load_dwordx4 v124, s[8:11], s62 offen offset:0 lds
  v_fmac_f32 v156, v73, v73
  v_fmac_f32 v155, v74, v74
  v_fmac_f32_e64 v156, v75, v75
  v_mfma_f32_32x32x16_bf16 v[48:63], v[108:111], a[108:111], v[48:63]
  v_fmac_f32 v155, v76, v76
  v_fmac_f32 v156, v77, v77
  v_fmac_f32 v155, v78, v78
  v_fmac_f32 v156, v79, v79
  v_fmac_f32 v155, v80, v80
  s_waitcnt lgkmcnt(1)
  v_mfma_f32_32x32x16_bf16 v[0:15], v[96:99], a[112:115], v[0:15]
  ds_read_b64_tr_b16 v[104:105], v139 offset:40960
  ds_read_b64_tr_b16 v[106:107], v139 offset:41984
  ds_read_b64_tr_b16 v[108:109], v141 offset:40960
  ds_read_b64_tr_b16 v[110:111], v141 offset:41984
  v_fmac_f32 v156, v81, v81
  s_waitcnt lgkmcnt(4)
  v_mfma_f32_32x32x16_bf16 v[16:31], v[96:99], a[116:119], v[16:31]
  ds_read_b128 a[120:123], v137 offset:32768
  ds_read_b128 a[124:127], v137 offset:36864
  buffer_load_dwordx4 v125, s[8:11], s62 offen offset:1024 lds
  v_fmac_f32 v155, v82, v82
  v_fmac_f32 v156, v83, v83
  v_add_f32_e64 v155, v155, v156
  v_mfma_f32_32x32x16_bf16 v[32:47], v[100:103], a[112:115], v[32:47]
  v_xor_b32 v134, 0x10000, v134
  v_xor_b32 v135, 0x10000, v135
  v_xor_b32 v136, 0x10000, v136
  v_xor_b32 v137, 0x10000, v137
  buffer_load_dwordx4 v126, s[8:11], s62 offen offset:2048 lds
  v_mfma_f32_16x16x32_bf16 v[112:115], v[120:123], v[96:99], v[112:115]
  v_add_f32_dpp v155, v155, v155 row_ror:8 row_mask:0xf bank_mask:0xf
  s_nop 1
  v_add_f32_dpp v155, v155, v155 row_ror:4 row_mask:0xf bank_mask:0xf
  v_mfma_f32_32x32x16_bf16 v[48:63], v[100:103], a[116:119], v[48:63]
  v_xor_b32 v138, 0x10000, v138
  v_xor_b32 v139, 0x10000, v139
  v_xor_b32 v140, 0x10000, v140
  v_xor_b32 v141, 0x10000, v141
  v_add_f32_dpp v155, v155, v155 row_ror:2 row_mask:0xf bank_mask:0xf
  s_nop 1
  v_add_f32_dpp v155, v155, v155 row_ror:1 row_mask:0xf bank_mask:0xf
  v_mfma_f32_16x16x32_bf16 v[116:119], v[120:123], v[100:103], v[116:119]
  v_mov_b32_e64 v154, v155
  s_waitcnt lgkmcnt(1)
  v_mfma_f32_32x32x16_bf16 v[0:15], v[104:107], a[120:123], v[0:15]
  s_waitcnt lgkmcnt(0)
  s_waitcnt vmcnt(11)
  s_barrier
  ds_read_b64_tr_b16 v[96:97], v138 offset:0
  ds_read_b64_tr_b16 v[98:99], v138 offset:1024
  ds_read_b64_tr_b16 v[100:101], v140 offset:0
  ds_read_b64_tr_b16 v[102:103], v140 offset:1024
  v_mfma_f32_32x32x16_bf16 v[16:31], v[104:107], a[124:127], v[16:31]
  ds_read_b128 a[128:131], v134 offset:0
  ds_read_b128 a[132:135], v134 offset:4096
  buffer_load_dwordx4 v127, s[8:11], s62 offen offset:3072 lds
  s_add_u32 m0, s89, 65536
  s_add_u32 s62, s62, 128
  v_permlane16_swap_b32 v155, v154
  v_mfma_f32_32x32x16_bf16 v[32:47], v[108:111], a[120:123], v[32:47]
  buffer_load_dwordx4 v128, s[12:15], s63 offen offset:0 lds
  v_add_f32 v155, v155, v154
  v_mul_f32 v155, 0x3acccccd, v155
  v_add_f32 v156, 0x3727c5ac, v155
  v_rsq_f32_e64 v85, v156
  v_mfma_f32_32x32x16_bf16 v[48:63], v[108:111], a[124:127], v[48:63]
  v_mov_b32_e64 v84, v158
  v_lshrrev_b32 v154, 1, v190
  s_lshl_b32 s98, s98, 4
  s_add_u32 s98, s98, 65536
  s_mov_b32 s78, 1
  s_waitcnt lgkmcnt(1)
  v_mfma_f32_32x32x16_bf16 v[0:15], v[96:99], a[128:131], v[0:15]
  ds_read_b64_tr_b16 v[104:105], v139 offset:0
  ds_read_b64_tr_b16 v[106:107], v139 offset:1024
  ds_read_b64_tr_b16 v[108:109], v141 offset:0
  ds_read_b64_tr_b16 v[110:111], v141 offset:1024
  s_mov_b32 s79, 1
  s_waitcnt lgkmcnt(4)
  v_mfma_f32_32x32x16_bf16 v[16:31], v[96:99], a[132:135], v[16:31]
  ds_read_b128 a[136:139], v135 offset:0
  ds_read_b128 a[140:143], v135 offset:4096
  buffer_load_dwordx4 v129, s[12:15], s63 offen offset:1024 lds
  v_cmp_eq_u32 vcc, 0, v189
  s_mov_b32 s97, 0
  s_cbranch_vccz Lpoll_729008_ok
Lpoll_729008:
  s_sleep 1
  buffer_load_dword v189, v188, s[32:35], 0 offen sc1
  s_add_u32 s97, s97, 1
  s_waitcnt vmcnt(0)
  v_cmp_eq_u32_e64 vcc, 0, v189
  s_cmp_gt_u32 s97, 32768
  s_cbranch_scc1 Lpoll_729008_ok
  s_cbranch_vccnz Lpoll_729008
Lpoll_729008_ok:
  v_mfma_f32_32x32x16_bf16 v[32:47], v[100:103], a[128:131], v[32:47]
  buffer_load_dwordx4 v130, s[12:15], s63 offen offset:2048 lds
  v_readfirstlane_b32 s77, v189
  s_nop 1
  v_mov_b32 v86, s77
  v_mov_b32 v87, s77
  v_mfma_f32_16x16x32_bf16 v[112:115], v[120:123], v[96:99], v[112:115]
  s_mov_b64 exec, s[78:79]
  buffer_store_dwordx4 v[84:87], v154, s[20:23], s98 offen sc1
  s_mov_b64 exec, -1
  v_mfma_f32_32x32x16_bf16 v[48:63], v[100:103], a[132:135], v[48:63]
  v_lshrrev_b32 v80, 4, v190
  v_lshlrev_b32 v80, 3, v80
  v_bfe_u32 v81, v190, 2, 2
  v_add_u32 v80, v80, v81
  v_lshlrev_b32 v80, 7, v80
  v_and_b32 v81, 3, v190
  v_mfma_f32_16x16x32_bf16 v[116:119], v[120:123], v[100:103], v[116:119]
  v_lshl_add_u32 v80, v81, 3, v80
  s_waitcnt lgkmcnt(0)
  v_mfma_f32_32x32x16_bf16 v[0:15], v[104:107], a[136:139], v[0:15]
  ds_read_b64_tr_b16 v[96:97], v138 offset:8192
  ds_read_b64_tr_b16 v[98:99], v138 offset:9216
  ds_read_b64_tr_b16 v[100:101], v140 offset:8192
  ds_read_b64_tr_b16 v[102:103], v140 offset:9216
  s_add_u32 s72, s88, 131072
  v_mfma_f32_32x32x16_bf16 v[16:31], v[104:107], a[140:143], v[16:31]
  ds_read_b128 a[144:147], v136 offset:0
  ds_read_b128 a[148:151], v136 offset:4096
  buffer_load_dwordx4 v131, s[12:15], s63 offen offset:3072 lds
  s_add_u32 s63, s63, 245760
  s_cmp_eq_u32 s62, s36
  s_cselect_b32 s62, s37, s62
  s_cselect_b32 s63, s38, s63
  v_mfma_f32_32x32x16_bf16 v[32:47], v[108:111], a[136:139], v[32:47]
  s_add_u32 m0, s88, 98304
  s_nop 0
  buffer_load_dwordx4 v124, s[8:11], s62 offen offset:0 lds
  v_add_u32_e64 v80, s72, v80
  s_mul_i32 s70, s80, 40
  s_lshl_b32 s71, s81, 2
  v_mfma_f32_32x32x16_bf16 v[48:63], v[108:111], a[140:143], v[48:63]
  s_add_u32 s70, s70, s71
  s_lshl_b32 s70, s70, 10
  s_add_u32 s70, s70, 1048576
  s_mov_b32 s28, s56
  s_mov_b32 s29, s57
  s_waitcnt lgkmcnt(1)
  v_mfma_f32_32x32x16_bf16 v[0:15], v[96:99], a[144:147], v[0:15]
  ds_read_b64_tr_b16 v[104:105], v139 offset:8192
  ds_read_b64_tr_b16 v[106:107], v139 offset:9216
  ds_read_b64_tr_b16 v[108:109], v141 offset:8192
  ds_read_b64_tr_b16 v[110:111], v141 offset:9216
  s_mov_b32 s31, 0x20000
  s_waitcnt lgkmcnt(4)
  v_mfma_f32_32x32x16_bf16 v[16:31], v[96:99], a[148:151], v[16:31]
  ds_read_b128 a[152:155], v137 offset:0
  ds_read_b128 a[156:159], v137 offset:4096
  buffer_load_dwordx4 v125, s[8:11], s62 offen offset:1024 lds
  s_cmp_lt_u32 s99, 740
  s_cselect_b32 s30, 24117248, 0
  v_mfma_f32_32x32x16_bf16 v[32:47], v[100:103], a[144:147], v[32:47]
  buffer_load_dwordx4 v126, s[8:11], s62 offen offset:2048 lds
  ds_read_b64_tr_b16 v[64:65], v80 offset:0
  ds_read_b64_tr_b16 v[66:67], v80 offset:512
  v_mfma_f32_16x16x32_bf16 v[112:115], v[120:123], v[96:99], v[112:115]
  ds_read_b64_tr_b16 v[68:69], v80 offset:32
  ds_read_b64_tr_b16 v[70:71], v80 offset:544
  v_mfma_f32_32x32x16_bf16 v[48:63], v[100:103], a[148:151], v[48:63]
  ds_read_b64_tr_b16 v[72:73], v80 offset:64
  ds_read_b64_tr_b16 v[74:75], v80 offset:576
  ds_read_b64_tr_b16 v[76:77], v80 offset:96
  ds_read_b64_tr_b16 v[78:79], v80 offset:608
  s_waitcnt lgkmcnt(6)
  buffer_store_dwordx4 v[64:67], v171, s[28:31], s70 offen offset:0 sc1
  v_mfma_f32_16x16x32_bf16 v[116:119], v[120:123], v[100:103], v[116:119]
  v_mfma_f32_32x32x16_bf16 v[0:15], v[104:107], a[152:155], v[0:15]
  s_waitcnt lgkmcnt(0)
  s_waitcnt vmcnt(13)
  s_barrier
  ds_read_b64_tr_b16 v[96:97], v138 offset:32768
  ds_read_b64_tr_b16 v[98:99], v138 offset:33792
  ds_read_b64_tr_b16 v[100:101], v140 offset:32768
  ds_read_b64_tr_b16 v[102:103], v140 offset:33792
  v_mfma_f32_32x32x16_bf16 v[16:31], v[104:107], a[156:159], v[16:31]
  ds_read_b128 a[160:163], v134 offset:32768
  ds_read_b128 a[164:167], v134 offset:36864
  buffer_store_dwordx4 v[68:71], v171, s[28:31], s70 offen offset:1024 sc1
  v_mfma_f32_32x32x16_bf16 v[32:47], v[108:111], a[152:155], v[32:47]
  v_mfma_f32_32x32x16_bf16 v[48:63], v[108:111], a[156:159], v[48:63]
  buffer_store_dwordx4 v[72:75], v171, s[28:31], s70 offen offset:2048 sc1
  s_waitcnt lgkmcnt(1)
  v_mfma_f32_32x32x16_bf16 v[0:15], v[96:99], a[160:163], v[0:15]
  ds_read_b64_tr_b16 v[104:105], v139 offset:32768
  ds_read_b64_tr_b16 v[106:107], v139 offset:33792
  ds_read_b64_tr_b16 v[108:109], v141 offset:32768
  ds_read_b64_tr_b16 v[110:111], v141 offset:33792
  buffer_store_dwordx4 v[76:79], v171, s[28:31], s70 offen offset:3072 sc1
  s_waitcnt lgkmcnt(4)
  v_mfma_f32_32x32x16_bf16 v[16:31], v[96:99], a[164:167], v[16:31]
  ds_read_b128 a[168:171], v135 offset:32768
  ds_read_b128 a[172:175], v135 offset:36864
  buffer_load_dwordx4 v127, s[8:11], s62 offen offset:3072 lds
  s_add_u32 m0, s89, 98304
  s_add_u32 s62, s62, 128
  v_mfma_f32_32x32x16_bf16 v[32:47], v[100:103], a[160:163], v[32:47]
  buffer_load_dwordx4 v128, s[12:15], s63 offen offset:0 lds
  v_mfma_f32_16x16x32_bf16 v[112:115], v[120:123], v[96:99], v[112:115]
  buffer_load_dwordx4 v129, s[12:15], s63 offen offset:1024 lds
  v_mfma_f32_32x32x16_bf16 v[48:63], v[100:103], a[164:167], v[48:63]
  buffer_load_dwordx4 v130, s[12:15], s63 offen offset:2048 lds
  v_mfma_f32_16x16x32_bf16 v[116:119], v[120:123], v[100:103], v[116:119]
  s_waitcnt lgkmcnt(1)
  v_mfma_f32_32x32x16_bf16 v[0:15], v[104:107], a[168:171], v[0:15]
  ds_read_b64_tr_b16 v[96:97], v138 offset:40960
  ds_read_b64_tr_b16 v[98:99], v138 offset:41984
  ds_read_b64_tr_b16 v[100:101], v140 offset:40960
  ds_read_b64_tr_b16 v[102:103], v140 offset:41984
  s_waitcnt lgkmcnt(4)
  v_mfma_f32_32x32x16_bf16 v[16:31], v[104:107], a[172:175], v[16:31]
  ds_read_b128 a[176:179], v136 offset:32768
  ds_read_b128 a[180:183], v136 offset:36864
  buffer_load_dwordx4 v131, s[12:15], s63 offen offset:3072 lds
  s_add_u32 s63, s63, 245760
  s_cmp_eq_u32 s62, s36
  s_cselect_b32 s62, s37, s62
  s_cselect_b32 s63, s38, s63
  v_mfma_f32_32x32x16_bf16 v[32:47], v[108:111], a[168:171], v[32:47]
  s_add_u32 m0, s88, 0
  s_nop 0
  buffer_load_dwordx4 v124, s[8:11], s62 offen offset:0 lds
  v_mfma_f32_32x32x16_bf16 v[48:63], v[108:111], a[172:175], v[48:63]
  s_waitcnt lgkmcnt(1)
  v_mfma_f32_32x32x16_bf16 v[0:15], v[96:99], a[176:179], v[0:15]
  ds_read_b64_tr_b16 v[104:105], v139 offset:40960
  ds_read_b64_tr_b16 v[106:107], v139 offset:41984
  ds_read_b64_tr_b16 v[108:109], v141 offset:40960
  ds_read_b64_tr_b16 v[110:111], v141 offset:41984
  s_waitcnt lgkmcnt(4)
  v_mfma_f32_32x32x16_bf16 v[16:31], v[96:99], a[180:183], v[16:31]
  ds_read_b128 a[184:187], v137 offset:32768
  ds_read_b128 a[188:191], v137 offset:36864
  buffer_load_dwordx4 v125, s[8:11], s62 offen offset:1024 lds
  v_mfma_f32_32x32x16_bf16 v[32:47], v[100:103], a[176:179], v[32:47]
  v_xor_b32 v134, 0x10000, v134
  v_xor_b32 v135, 0x10000, v135
  v_xor_b32 v136, 0x10000, v136
  v_xor_b32 v137, 0x10000, v137
  buffer_load_dwordx4 v126, s[8:11], s62 offen offset:2048 lds
  v_mfma_f32_16x16x32_bf16 v[112:115], v[120:123], v[96:99], v[112:115]
  v_mfma_f32_32x32x16_bf16 v[48:63], v[100:103], a[180:183], v[48:63]
  v_xor_b32 v138, 0x10000, v138
  v_xor_b32 v139, 0x10000, v139
  v_xor_b32 v140, 0x10000, v140
  v_xor_b32 v141, 0x10000, v141
  v_mfma_f32_16x16x32_bf16 v[116:119], v[120:123], v[100:103], v[116:119]
  s_waitcnt lgkmcnt(1)
  v_mfma_f32_32x32x16_bf16 v[0:15], v[104:107], a[184:187], v[0:15]
  s_waitcnt lgkmcnt(0)
  s_waitcnt vmcnt(15)
  s_barrier
  ds_read_b64_tr_b16 v[96:97], v138 offset:0
  ds_read_b64_tr_b16 v[98:99], v138 offset:1024
  ds_read_b64_tr_b16 v[100:101], v140 offset:0
  ds_read_b64_tr_b16 v[102:103], v140 offset:1024
  v_mfma_f32_32x32x16_bf16 v[16:31], v[104:107], a[188:191], v[16:31]
  ds_read_b128 a[192:195], v134 offset:0
  ds_read_b128 a[196:199], v134 offset:4096
  buffer_load_dwordx4 v127, s[8:11], s62 offen offset:3072 lds
  s_add_u32 m0, s89, 0
  s_add_u32 s62, s62, 128
  v_mfma_f32_32x32x16_bf16 v[32:47], v[108:111], a[184:187], v[32:47]
  buffer_load_dwordx4 v128, s[12:15], s63 offen offset:0 lds
  v_mfma_f32_32x32x16_bf16 v[48:63], v[108:111], a[188:191], v[48:63]
  s_waitcnt lgkmcnt(1)
  v_mfma_f32_32x32x16_bf16 v[0:15], v[96:99], a[192:195], v[0:15]
  ds_read_b64_tr_b16 v[104:105], v139 offset:0
  ds_read_b64_tr_b16 v[106:107], v139 offset:1024
  ds_read_b64_tr_b16 v[108:109], v141 offset:0
  ds_read_b64_tr_b16 v[110:111], v141 offset:1024
  s_waitcnt lgkmcnt(4)
  v_mfma_f32_32x32x16_bf16 v[16:31], v[96:99], a[196:199], v[16:31]
  ds_read_b128 a[200:203], v135 offset:0
  ds_read_b128 a[204:207], v135 offset:4096
  buffer_load_dwordx4 v129, s[12:15], s63 offen offset:1024 lds
  v_mfma_f32_32x32x16_bf16 v[32:47], v[100:103], a[192:195], v[32:47]
  buffer_load_dwordx4 v130, s[12:15], s63 offen offset:2048 lds
  v_mfma_f32_16x16x32_bf16 v[112:115], v[120:123], v[96:99], v[112:115]
  v_mfma_f32_32x32x16_bf16 v[48:63], v[100:103], a[196:199], v[48:63]
  v_mfma_f32_16x16x32_bf16 v[116:119], v[120:123], v[100:103], v[116:119]
  s_waitcnt lgkmcnt(1)
  v_mfma_f32_32x32x16_bf16 v[0:15], v[104:107], a[200:203], v[0:15]
  ds_read_b64_tr_b16 v[96:97], v138 offset:8192
  ds_read_b64_tr_b16 v[98:99], v138 offset:9216
  ds_read_b64_tr_b16 v[100:101], v140 offset:8192
  ds_read_b64_tr_b16 v[102:103], v140 offset:9216
  s_lshl_b32 s98, s58, 1
  s_waitcnt lgkmcnt(4)
  v_mfma_f32_32x32x16_bf16 v[16:31], v[104:107], a[204:207], v[16:31]
  ds_read_b128 a[208:211], v136 offset:0
  ds_read_b128 a[212:215], v136 offset:4096
  buffer_load_dwordx4 v131, s[12:15], s63 offen offset:3072 lds
  s_add_u32 s63, s63, 245760
  s_cmp_eq_u32 s62, s36
  s_cselect_b32 s62, s37, s62
  s_cselect_b32 s63, s38, s63
  v_mfma_f32_32x32x16_bf16 v[32:47], v[108:111], a[200:203], v[32:47]
  s_add_u32 m0, s88, 32768
  s_nop 0
  buffer_load_dwordx4 v124, s[8:11], s62 offen offset:0 lds
  s_add_u32 s98, s98, s60
  s_lshl_b32 s98, s98, 10
  s_add_u32 s98, s98, 65536
  v_mfma_f32_32x32x16_bf16 v[48:63], v[108:111], a[204:207], v[48:63]
  v_and_b32 v180, 31, v190
  v_lshlrev_b32_e64 v180, 4, v180
  s_waitcnt lgkmcnt(1)
  v_mfma_f32_32x32x16_bf16 v[0:15], v[96:99], a[208:211], v[0:15]
  ds_read_b64_tr_b16 v[104:105], v139 offset:8192
  ds_read_b64_tr_b16 v[106:107], v139 offset:9216
  ds_read_b64_tr_b16 v[108:109], v141 offset:8192
  ds_read_b64_tr_b16 v[110:111], v141 offset:9216
  buffer_load_dwordx4 v[148:151], v180, s[20:23], s98 offen offset:0 sc1
  s_waitcnt lgkmcnt(4)
  v_mfma_f32_32x32x16_bf16 v[16:31], v[96:99], a[212:215], v[16:31]
  ds_read_b128 a[216:219], v137 offset:0
  ds_read_b128 a[220:223], v137 offset:4096
  v_mfma_f32_32x32x16_bf16 v[32:47], v[100:103], a[208:211], v[32:47]
  buffer_load_dwordx4 v[156:159], v180, s[20:23], s98 offen offset:512 sc1
  v_mfma_f32_16x16x32_bf16 v[112:115], v[120:123], v[96:99], v[112:115]
  buffer_load_dwordx4 v125, s[8:11], s62 offen offset:1024 lds
  v_mfma_f32_32x32x16_bf16 v[48:63], v[100:103], a[212:215], v[48:63]
  buffer_load_dwordx4 v126, s[8:11], s62 offen offset:2048 lds
  v_mfma_f32_16x16x32_bf16 v[116:119], v[120:123], v[100:103], v[116:119]
  s_waitcnt lgkmcnt(1)
  v_mfma_f32_32x32x16_bf16 v[0:15], v[104:107], a[216:219], v[0:15]
  s_waitcnt lgkmcnt(0)
  s_waitcnt vmcnt(13)
  s_barrier
  ds_read_b64_tr_b16 v[96:97], v138 offset:32768
  ds_read_b64_tr_b16 v[98:99], v138 offset:33792
  ds_read_b64_tr_b16 v[100:101], v140 offset:32768
  ds_read_b64_tr_b16 v[102:103], v140 offset:33792
  v_mfma_f32_32x32x16_bf16 v[16:31], v[104:107], a[220:223], v[16:31]
  ds_read_b128 a[224:227], v134 offset:32768
  ds_read_b128 a[228:231], v134 offset:36864
  buffer_load_dwordx4 v127, s[8:11], s62 offen offset:3072 lds
  s_add_u32 m0, s89, 32768
  s_add_u32 s62, s62, 128
  v_mfma_f32_32x32x16_bf16 v[32:47], v[108:111], a[216:219], v[32:47]
  buffer_load_dwordx4 v128, s[12:15], s63 offen offset:0 lds
  v_mfma_f32_32x32x16_bf16 v[48:63], v[108:111], a[220:223], v[48:63]
  s_waitcnt lgkmcnt(1)
  v_mfma_f32_32x32x16_bf16 v[0:15], v[96:99], a[224:227], v[0:15]
  ds_read_b64_tr_b16 v[104:105], v139 offset:32768
  ds_read_b64_tr_b16 v[106:107], v139 offset:33792
  ds_read_b64_tr_b16 v[108:109], v141 offset:32768
  ds_read_b64_tr_b16 v[110:111], v141 offset:33792
  s_lshl_b32 s99, s99, 7
  s_waitcnt lgkmcnt(4)
  v_mfma_f32_32x32x16_bf16 v[16:31], v[96:99], a[228:231], v[16:31]
  ds_read_b128 a[232:235], v135 offset:32768
  ds_read_b128 a[236:239], v135 offset:36864
  buffer_load_dwordx4 v129, s[12:15], s63 offen offset:1024 lds
  s_add_u32 s100, s99, 262144
  v_mov_b32 v189, s77
  s_mov_b64 exec, 1
  buffer_store_dword v189, off, s[20:23], s100 sc1
  s_mov_b64 exec, -1
  v_mfma_f32_32x32x16_bf16 v[32:47], v[100:103], a[224:227], v[32:47]
  buffer_load_dwordx4 v130, s[12:15], s63 offen offset:2048 lds
  s_lshl_b32 s41, s58, 1
  s_add_u32 s41, s41, s60
  s_lshl_b32 s41, s41, 4
  s_add_u32 s41, s41, s59
  s_lshl_b32 s41, s41, 1
  v_mfma_f32_16x16x32_bf16 v[112:115], v[120:123], v[96:99], v[112:115]
  s_add_u32 s41, s41, s61
  s_lshl_b32 s41, s41, 7
  v_mfma_f32_32x32x16_bf16 v[48:63], v[100:103], a[228:231], v[48:63]
  s_lshl_b32 s53, s61, 2
  s_add_u32 s53, s53, s60
  v_lshrrev_b32 v177, 1, v190
  v_min_u32 v177, 18, v177
  v_lshlrev_b32 v178, 3, v177
  v_add_u32_e64 v178, s53, v178
  v_mfma_f32_16x16x32_bf16 v[116:119], v[120:123], v[100:103], v[116:119]
  v_subrev_u32 v188, 54, v178
  s_waitcnt lgkmcnt(0)
  v_mfma_f32_32x32x16_bf16 v[0:15], v[104:107], a[232:235], v[0:15]
  ds_read_b64_tr_b16 v[96:97], v138 offset:40960
  ds_read_b64_tr_b16 v[98:99], v138 offset:41984
  ds_read_b64_tr_b16 v[100:101], v140 offset:40960
  ds_read_b64_tr_b16 v[102:103], v140 offset:41984
  v_mfma_f32_32x32x16_bf16 v[16:31], v[104:107], a[236:239], v[16:31]
  ds_read_b128 a[240:243], v136 offset:32768
  ds_read_b128 a[244:247], v136 offset:36864
  buffer_load_dwordx4 v131, s[12:15], s63 offen offset:3072 lds
  s_add_u32 s63, s63, 245760
  s_cmp_eq_u32 s62, s36
  s_cselect_b32 s62, s37, s62
  s_cselect_b32 s63, s38, s63
  v_mfma_f32_32x32x16_bf16 v[32:47], v[108:111], a[232:235], v[32:47]
  s_add_u32 m0, s92, 131072
  s_nop 0
  buffer_load_dwordx4 v132, s[16:19], s64 offen lds
  v_cmp_lt_u32 vcc, 6, v177
  s_mul_i32 s72, s87, 5
  s_lshr_b32 s72, s72, 2
  v_cndmask_b32 v178, v178, v188, vcc
  v_mfma_f32_32x32x16_bf16 v[48:63], v[108:111], a[236:239], v[48:63]
  v_min_u32 v178, 53, v178
  v_lshlrev_b32 v188, 2, v177
  v_add_u32 v188, s3, v188
  v_subrev_u32 v188, 2, v188
  s_waitcnt lgkmcnt(1)
  v_mfma_f32_32x32x16_bf16 v[0:15], v[96:99], a[240:243], v[0:15]
  ds_read_b64_tr_b16 v[104:105], v139 offset:40960
  ds_read_b64_tr_b16 v[106:107], v139 offset:41984
  ds_read_b64_tr_b16 v[108:109], v141 offset:40960
  ds_read_b64_tr_b16 v[110:111], v141 offset:41984
  s_waitcnt lgkmcnt(4)
  v_mfma_f32_32x32x16_bf16 v[16:31], v[96:99], a[244:247], v[16:31]
  ds_read_b128 a[248:251], v137 offset:32768
  ds_read_b128 a[252:255], v137 offset:36864
  buffer_load_dwordx4 v133, s[16:19], s64 offen offset:1024 lds
  s_add_u32 s64, s64, 221184
  s_cmp_eq_u32 s64, s82
  s_cselect_b32 s64, s83, s64
  v_mfma_f32_32x32x16_bf16 v[32:47], v[100:103], a[240:243], v[32:47]
  v_xor_b32 v134, 0x10000, v134
  v_xor_b32 v135, 0x10000, v135
  v_xor_b32 v136, 0x10000, v136
  v_xor_b32 v137, 0x10000, v137
  s_add_u32 m0, s92, 139264
  s_nop 0
  buffer_load_dwordx4 v132, s[16:19], s64 offen lds
  v_mfma_f32_16x16x32_bf16 v[112:115], v[120:123], v[96:99], v[112:115]
  v_cmp_lt_u32 vcc, 13, v177
  v_and_b32 v177, 1, v190
  v_add_u32 v177, s72, v177
  v_cndmask_b32_e64 v178, v178, v188, vcc
  v_mfma_f32_32x32x16_bf16 v[48:63], v[100:103], a[244:247], v[48:63]
  v_xor_b32 v138, 0x10000, v138
  v_xor_b32 v139, 0x10000, v139
  v_xor_b32 v140, 0x10000, v140
  v_xor_b32 v141, 0x10000, v141
  v_mul_u32_u24 v178, 10, v178
  v_min_u32 v177, 9, v177
  v_mfma_f32_16x16x32_bf16 v[116:119], v[120:123], v[100:103], v[116:119]
  v_add_u32 v177, v177, v178
  s_waitcnt lgkmcnt(0)
  v_mfma_f32_32x32x16_bf16 v[0:15], v[104:107], a[248:251], v[0:15]
  s_waitcnt vmcnt(14)
  s_barrier
  ds_read_b64_tr_b16 v[96:97], v138 offset:0
  ds_read_b64_tr_b16 v[98:99], v138 offset:1024
  ds_read_b64_tr_b16 v[100:101], v140 offset:0
  ds_read_b64_tr_b16 v[102:103], v140 offset:1024
  v_mfma_f32_32x32x16_bf16 v[16:31], v[104:107], a[252:255], v[16:31]
  ds_read_b128 v[192:195], v134 offset:0
  ds_read_b128 v[196:199], v134 offset:4096
  buffer_load_dwordx4 v133, s[16:19], s64 offen offset:1024 lds
  s_add_u32 s64, s64, 221184
  s_cmp_eq_u32 s64, s82
  s_cselect_b32 s64, s83, s64
  v_mfma_f32_32x32x16_bf16 v[32:47], v[108:111], a[248:251], v[32:47]
  s_add_u32 m0, s92, 147456
  s_nop 0
  buffer_load_dwordx4 v132, s[16:19], s64 offen lds
  v_lshlrev_b32 v177, 7, v177
  v_add_u32 v188, 262144, v177
  s_mul_i32 s72, s87, 5
  v_mfma_f32_32x32x16_bf16 v[48:63], v[108:111], a[252:255], v[48:63]
  s_lshl_b32 s72, s72, 10
  s_add_u32 s72, s72, 1048576
  s_mul_i32 s94, s53, 40960
  s_add_u32 s94, s94, s72
  s_mul_i32 s52, s3, 40960
  s_waitcnt lgkmcnt(1)
  v_mfma_f32_32x32x16_bf16 v[0:15], v[96:99], v[192:195], v[0:15]
  ds_read_b64_tr_b16 v[104:105], v139 offset:0
  ds_read_b64_tr_b16 v[106:107], v139 offset:1024
  ds_read_b64_tr_b16 v[108:109], v141 offset:0
  ds_read_b64_tr_b16 v[110:111], v141 offset:1024
  s_add_u32 s52, s52, s72
  s_waitcnt lgkmcnt(4)
  v_mfma_f32_32x32x16_bf16 v[16:31], v[96:99], v[196:199], v[16:31]
  ds_read_b128 v[200:203], v135 offset:0
  ds_read_b128 v[204:207], v135 offset:4096
  buffer_load_dwordx4 v133, s[16:19], s64 offen offset:1024 lds
  s_add_u32 s64, s64, 221184
  s_cmp_eq_u32 s64, s82
  s_cselect_b32 s64, s83, s64
  v_mfma_f32_32x32x16_bf16 v[32:47], v[100:103], v[192:195], v[32:47]
  s_add_u32 m0, s92, 155648
  s_nop 0
  buffer_load_dwordx4 v132, s[16:19], s64 offen lds
  v_mfma_f32_16x16x32_bf16 v[112:115], v[120:123], v[96:99], v[112:115]
  v_mfma_f32_32x32x16_bf16 v[48:63], v[100:103], v[196:199], v[48:63]
  v_mfma_f32_16x16x32_bf16 v[116:119], v[120:123], v[100:103], v[116:119]
  s_waitcnt lgkmcnt(1)
  v_mfma_f32_32x32x16_bf16 v[0:15], v[104:107], v[200:203], v[0:15]
  ds_read_b64_tr_b16 v[96:97], v138 offset:8192
  ds_read_b64_tr_b16 v[98:99], v138 offset:9216
  ds_read_b64_tr_b16 v[100:101], v140 offset:8192
  ds_read_b64_tr_b16 v[102:103], v140 offset:9216
  s_waitcnt lgkmcnt(4)
  v_mfma_f32_32x32x16_bf16 v[16:31], v[104:107], v[204:207], v[16:31]
  ds_read_b128 v[208:211], v136 offset:0
  ds_read_b128 v[212:215], v136 offset:4096
  buffer_load_dwordx4 v133, s[16:19], s64 offen offset:1024 lds
  s_add_u32 s64, s64, 221184
  s_cmp_eq_u32 s64, s82
  s_cselect_b32 s64, s83, s64
  v_mfma_f32_32x32x16_bf16 v[32:47], v[108:111], v[200:203], v[32:47]
  s_waitcnt vmcnt(17)
  v_cmp_ne_u32_e64 vcc, s77, v151
  s_waitcnt vmcnt(16)
  v_cmp_ne_u32 s[78:79], s77, v159
  s_nop 0
  s_or_b64 vcc, vcc, s[78:79]
  s_mov_b32 s97, 0
  s_cbranch_vccz Lst_733009_ok
Lst_733009:
  s_sleep 1
  buffer_load_dwordx4 v[148:151], v180, s[20:23], s98 offen offset:0 sc1
  buffer_load_dwordx4 v[156:159], v180, s[20:23], s98 offen offset:512 sc1
  s_add_u32 s97, s97, 1
  s_waitcnt vmcnt(0)
  v_cmp_ne_u32_e64 vcc, s77, v151
  v_cmp_ne_u32 s[78:79], s77, v159
  s_nop 0
  s_or_b64 vcc, vcc, s[78:79]
  s_cmp_gt_u32 s97, 32768
  s_cbranch_scc1 Lst_733009_ok
  s_cbranch_vccnz Lst_733009
Lst_733009_ok:
  v_mfma_f32_32x32x16_bf16 v[48:63], v[108:111], v[204:207], v[48:63]
  s_add_u32 m0, s92, 106496
  s_nop 0
  buffer_load_dwordx4 v132, s[16:19], s64 offen lds
  v_mul_f32_e64 v177, v149, v149
  s_waitcnt lgkmcnt(0)
  v_mfma_f32_32x32x16_bf16 v[0:15], v[96:99], v[208:211], v[0:15]
  ds_read_b64_tr_b16 v[104:105], v139 offset:8192
  ds_read_b64_tr_b16 v[106:107], v139 offset:9216
  ds_read_b64_tr_b16 v[108:109], v141 offset:8192
  ds_read_b64_tr_b16 v[110:111], v141 offset:9216
  v_mov_b32 v178, 0x3f800054
  v_mfma_f32_32x32x16_bf16 v[16:31], v[96:99], v[212:215], v[16:31]
  ds_read_b128 v[216:219], v137 offset:0
  ds_read_b128 v[220:223], v137 offset:4096
  buffer_load_dwordx4 v133, s[16:19], s64 offen offset:1024 lds
  s_add_u32 s64, s64, 221184
  s_cmp_eq_u32 s64, s82
  s_cselect_b32 s64, s83, s64
  v_mfma_f32_32x32x16_bf16 v[32:47], v[100:103], v[208:211], v[32:47]
  v_fmac_f32 v178, 0xb727c5ac, v177
  v_rsq_f32 v178, v178
  v_mov_b32 v147, v148
  v_mov_b32 v148, v149
  v_mfma_f32_16x16x32_bf16 v[112:115], v[120:123], v[96:99], v[112:115]
  s_add_u32 m0, s92, 114688
  s_nop 0
  buffer_load_dwordx4 v132, s[16:19], s64 offen lds
  v_mfma_f32_32x32x16_bf16 v[48:63], v[100:103], v[212:215], v[48:63]
  v_mul_f32 v178, v178, v148
  v_rcp_f32 v151, v178
  v_mul_f32 v149, 0xc0135761, v178
  v_mul_f32 v177, v178, v178
  v_mul_f32 v177, v177, v178
  v_mfma_f32_16x16x32_bf16 v[116:119], v[120:123], v[100:103], v[116:119]
  v_mul_f32 v150, 0xbdd2d3e8, v177
  s_waitcnt lgkmcnt(1)
  v_mfma_f32_32x32x16_bf16 v[0:15], v[104:107], v[216:219], v[0:15]
  s_waitcnt lgkmcnt(0)
  s_waitcnt vmcnt(11)
  s_barrier
  ds_read_b64_tr_b16 v[96:97], v138 offset:32768
  ds_read_b64_tr_b16 v[98:99], v138 offset:33792
  ds_read_b64_tr_b16 v[100:101], v140 offset:32768
  ds_read_b64_tr_b16 v[102:103], v140 offset:33792
  v_mfma_f32_32x32x16_bf16 v[16:31], v[104:107], v[220:223], v[16:31]
  ds_read_b128 v[224:227], v134 offset:32768
  ds_read_b128 v[228:231], v134 offset:36864
  v_cvt_pk_bf16_f32 v145, v147, v151
  v_lshlrev_b32_e64 v177, 16, v145
  v_and_b32 v178, 0xffff0000, v145
  v_sub_f32_e64 v147, v147, v177
  v_mfma_f32_32x32x16_bf16 v[32:47], v[108:111], v[216:219], v[32:47]
  buffer_load_dwordx4 v133, s[16:19], s64 offen offset:1024 lds
  s_add_u32 s64, s64, 221184
  s_cmp_eq_u32 s64, s82
  s_cselect_b32 s64, s83, s64
  v_sub_f32_e64 v178, v151, v178
  v_cvt_pk_bf16_f32 v144, v177, v147
  v_mfma_f32_32x32x16_bf16 v[48:63], v[108:111], v[220:223], v[48:63]
  v_cvt_pk_bf16_f32 v146, v178, 0
  v_mov_b32_e64 v147, 0
  v_mul_f32 v177, v157, v157
  v_mov_b32 v178, 0x3f800054
  s_waitcnt lgkmcnt(1)
  v_mfma_f32_32x32x16_bf16 v[0:15], v[96:99], v[224:227], v[0:15]
  ds_read_b64_tr_b16 v[104:105], v139 offset:32768
  ds_read_b64_tr_b16 v[106:107], v139 offset:33792
  ds_read_b64_tr_b16 v[108:109], v141 offset:32768
  ds_read_b64_tr_b16 v[110:111], v141 offset:33792
  v_fmac_f32 v178, 0xb727c5ac, v177
  s_waitcnt lgkmcnt(4)
  v_mfma_f32_32x32x16_bf16 v[16:31], v[96:99], v[228:231], v[16:31]
  ds_read_b128 v[232:235], v135 offset:32768
  ds_read_b128 v[236:239], v135 offset:36864
  s_add_u32 m0, s92, 122880
  s_nop 0
  buffer_load_dwordx4 v132, s[16:19], s64 offen lds
  v_mfma_f32_32x32x16_bf16 v[32:47], v[100:103], v[224:227], v[32:47]
  v_rsq_f32 v178, v178
  v_mov_b32 v155, v156
  v_mov_b32 v156, v157
  v_mul_f32 v178, v178, v156
  v_mfma_f32_16x16x32_bf16 v[112:115], v[120:123], v[96:99], v[112:115]
  v_rcp_f32_e64 v159, v178
  v_mfma_f32_32x32x16_bf16 v[48:63], v[100:103], v[228:231], v[48:63]
  v_mul_f32 v157, 0xc0135761, v178
  v_mul_f32 v177, v178, v178
  v_mul_f32 v177, v177, v178
  v_mul_f32 v158, 0xbdd2d3e8, v177
  v_cvt_pk_bf16_f32 v153, v155, v159
  v_lshlrev_b32 v177, 16, v153
  v_mfma_f32_16x16x32_bf16 v[116:119], v[120:123], v[100:103], v[116:119]
  buffer_load_dwordx4 v133, s[16:19], s64 offen offset:1024 lds
  s_add_u32 s64, s64, 221184
  s_cmp_eq_u32 s64, s82
  s_cselect_b32 s64, s83, s64
  s_waitcnt lgkmcnt(1)
  v_mfma_f32_32x32x16_bf16 v[0:15], v[104:107], v[232:235], v[0:15]
  ds_read_b64_tr_b16 v[96:97], v138 offset:40960
  ds_read_b64_tr_b16 v[98:99], v138 offset:41984
  ds_read_b64_tr_b16 v[100:101], v140 offset:40960
  ds_read_b64_tr_b16 v[102:103], v140 offset:41984
  v_and_b32 v178, 0xffff0000, v153
  s_waitcnt lgkmcnt(4)
  v_mfma_f32_32x32x16_bf16 v[16:31], v[104:107], v[236:239], v[16:31]
  ds_read_b128 v[240:243], v136 offset:32768
  ds_read_b128 v[244:247], v136 offset:36864
  v_sub_f32 v155, v155, v177
  v_sub_f32_e64 v178, v159, v178
  v_cvt_pk_bf16_f32 v152, v177, v155
  v_cvt_pk_bf16_f32 v154, v178, 0
  v_mfma_f32_32x32x16_bf16 v[32:47], v[108:111], v[232:235], v[32:47]
  v_mov_b32_e64 v155, 0
  v_mfma_f32_32x32x16_bf16 v[48:63], v[108:111], v[236:239], v[48:63]
  s_add_u32 m0, s92, 65536
  s_nop 0
  buffer_load_dwordx4 v132, s[16:19], s64 offen lds
  s_waitcnt lgkmcnt(1)
  v_mfma_f32_32x32x16_bf16 v[0:15], v[96:99], v[240:243], v[0:15]
  ds_read_b64_tr_b16 v[104:105], v139 offset:40960
  ds_read_b64_tr_b16 v[106:107], v139 offset:41984
  ds_read_b64_tr_b16 v[108:109], v141 offset:40960
  ds_read_b64_tr_b16 v[110:111], v141 offset:41984
  v_mfma_f32_16x16x32_bf16 v[112:115], v[120:123], v[96:99], v[112:115]
  buffer_load_dwordx4 v133, s[16:19], s64 offen offset:1024 lds
  s_add_u32 s64, s64, 221184
  s_cmp_eq_u32 s64, s82
  s_cselect_b32 s64, s83, s64
  s_waitcnt lgkmcnt(4)
  v_mfma_f32_32x32x16_bf16 v[16:31], v[96:99], v[244:247], v[16:31]
  ds_read_b128 v[248:251], v137 offset:32768
  ds_read_b128 v[252:255], v137 offset:36864
  v_mfma_f32_16x16x32_bf16 v[116:119], v[120:123], v[100:103], v[116:119]
  v_mfma_f32_32x32x16_bf16 v[32:47], v[100:103], v[240:243], v[32:47]
  v_add_u32 v186, 131072, v142
  v_add_u32 v187, 131072, v143
  v_mfma_f32_32x32x16_bf16 v[48:63], v[100:103], v[244:247], v[48:63]
  s_add_u32 m0, s92, 73728
  s_nop 0
  buffer_load_dwordx4 v132, s[16:19], s64 offen lds
  s_waitcnt lgkmcnt(1)
  v_mfma_f32_32x32x16_bf16 v[0:15], v[104:107], v[248:251], v[0:15]
  s_lshl_b32 s65, s3, 9
  s_add_u32 s65, s65, 98304
  v_lshl_add_u32 v181, v190, 2, s65
  ds_write_b32 v181, v112 offset:0
  ds_write_b32 v181, v116 offset:256
  s_waitcnt lgkmcnt(0)
  buffer_load_dwordx4 v133, s[16:19], s64 offen offset:1024 lds
  s_add_u32 s64, s64, 221184
  s_cmp_eq_u32 s64, s82
  s_cselect_b32 s64, s83, s64
  s_add_u32 m0, s92, 81920
  s_nop 0
  buffer_load_dwordx4 v132, s[16:19], s64 offen lds
  buffer_load_dwordx4 v133, s[16:19], s64 offen offset:1024 lds
  s_add_u32 s64, s64, 221184
  s_cmp_eq_u32 s64, s82
  s_cselect_b32 s64, s83, s64
  s_waitcnt vmcnt(12)
  s_barrier
  ds_read_b64_tr_b16 v[96:97], v186 offset:0
  ds_read_b64_tr_b16 v[98:99], v186 offset:512
  ds_read_b64_tr_b16 v[100:101], v187 offset:0
  ds_read_b64_tr_b16 v[102:103], v187 offset:512
  v_mfma_f32_32x32x16_bf16 v[16:31], v[104:107], v[252:255], v[16:31]
  v_mfma_f32_32x32x16_bf16 v[32:47], v[108:111], v[248:251], v[32:47]
  v_mfma_f32_32x32x16_bf16 v[48:63], v[108:111], v[252:255], v[48:63]
  s_waitcnt lgkmcnt(2)
  v_mfma_f32_32x32x16_bf16 v[64:79], v[96:99], a[0:3], 0
  ds_read_b64_tr_b16 v[104:105], v186 offset:4096
  ds_read_b64_tr_b16 v[106:107], v186 offset:4608
  buffer_load_dword v189, v188, s[20:23], 0 offen sc1
  v_and_b32 v181, 4294966783, v181
  ds_read2st64_b32 v[162:163], v181 offset0:0 offset1:2
  ds_read2st64_b32 v[166:167], v181 offset0:1 offset1:3
  v_mfma_f32_16x16x32_bf16 v[112:115], v[120:123], v[96:99], 0
  s_waitcnt lgkmcnt(1)
  v_add_f32_e64 v182, v162, v163
  v_mfma_f32_32x32x16_bf16 v[80:95], v[96:99], a[4:7], 0
  v_cvt_pk_bf16_f32 v160, v182, v182
  v_and_b32 v183, 0xffff0000, v160
  v_sub_f32_e64 v182, v182, v183
  v_cvt_pk_bf16_f32 v161, v182, 0
  v_mov_b32 v162, 0
  v_mov_b32 v163, 0
  v_mfma_f32_32x32x16_bf16 v[64:79], v[100:103], a[8:11], v[64:79]
  ds_read_b64_tr_b16 v[108:109], v187 offset:4096
  ds_read_b64_tr_b16 v[110:111], v187 offset:4608
  s_waitcnt lgkmcnt(2)
  v_add_f32 v182, v166, v167
  v_cvt_pk_bf16_f32 v164, v182, v182
  v_and_b32 v183, 0xffff0000, v164
  v_mfma_f32_32x32x16_bf16 v[80:95], v[100:103], a[12:15], v[80:95]
  s_sub_u32 s64, s64, s83
  s_add_u32 s64, s64, s93
  s_add_u32 s82, s93, 2211840
  s_cmp_lt_u32 s75, 27
  s_cselect_b32 s18, s18, 0
  s_add_u32 m0, s92, 0
  s_nop 0
  buffer_load_dwordx4 v132, s[16:19], s64 offen lds
  v_mfma_f32_16x16x32_bf16 v[112:115], v[120:123], v[104:107], v[112:115]
  v_sub_f32_e64 v182, v182, v183
  v_cvt_pk_bf16_f32 v165, v182, 0
  v_mfma_f32_32x32x16_bf16 v[64:79], v[104:107], a[16:19], v[64:79]
  ds_read_b64_tr_b16 v[96:97], v186 offset:8192
  ds_read_b64_tr_b16 v[98:99], v186 offset:8704
  v_mov_b32 v166, 0
  v_mov_b32 v167, 0
  v_mfma_f32_32x32x16_bf16 v[0:15], v[160:163], v[144:147], v[0:15]
  v_mfma_f32_32x32x16_bf16 v[16:31], v[160:163], v[152:155], v[16:31]
  v_mfma_f32_32x32x16_bf16 v[32:47], v[164:167], v[144:147], v[32:47]
  v_mfma_f32_32x32x16_bf16 v[48:63], v[164:167], v[152:155], v[48:63]
  s_lshl_b32 s98, s59, 1
  s_add_u32 s98, s98, s61
  s_lshl_b32 s98, s98, 18
  s_lshl_b32 s99, s58, 1
  s_add_u32 s99, s99, s60
  s_lshl_b32 s99, s99, 10
  v_mfma_f32_32x32x16_bf16 v[80:95], v[104:107], a[20:23], v[80:95]
  buffer_load_dwordx4 v133, s[16:19], s64 offen offset:1024 lds
  s_add_u32 s64, s64, 221184
  s_cmp_eq_u32 s64, s82
  s_cselect_b32 s64, s93, s64
  s_add_u32 s98, s98, s99
  s_waitcnt lgkmcnt(2)
  v_mfma_f32_32x32x16_bf16 v[64:79], v[108:111], a[24:27], v[64:79]
  ds_read_b64_tr_b16 v[100:101], v187 offset:8192
  ds_read_b64_tr_b16 v[102:103], v187 offset:8704
  s_add_u32 s98, s98, 4194304
  v_mul_f32 v184, s76, v148
  v_mul_f32 v185, s76, v156
  v_mul_f32_e64 v0, v184, v0
  v_mfma_f32_32x32x16_bf16 v[80:95], v[108:111], a[28:31], v[80:95]
  s_add_u32 m0, s92, 8192
  s_nop 0
  buffer_load_dwordx4 v132, s[16:19], s64 offen lds
  v_mul_f32 v1, v184, v1
  v_mul_f32 v2, v184, v2
  s_waitcnt lgkmcnt(2)
  v_mfma_f32_16x16x32_bf16 v[112:115], v[120:123], v[96:99], v[112:115]
  v_mul_f32 v3, v184, v3
  v_mul_f32 v4, v184, v4
  v_mfma_f32_32x32x16_bf16 v[64:79], v[96:99], a[32:35], v[64:79]
  ds_read_b64_tr_b16 v[104:105], v186 offset:12288
  ds_read_b64_tr_b16 v[106:107], v186 offset:12800
  buffer_load_dwordx4 v133, s[16:19], s64 offen offset:1024 lds
  s_add_u32 s64, s64, 221184
  s_cmp_eq_u32 s64, s82
  s_cselect_b32 s64, s93, s64
  v_mfma_f32_32x32x16_bf16 v[80:95], v[96:99], a[36:39], v[80:95]
  v_mul_f32 v5, v184, v5
  v_mul_f32 v6, v184, v6
  v_mul_f32 v7, v184, v7
  v_cvt_pk_bf16_f32 v0, v0, v1
  v_cvt_pk_bf16_f32 v1, v2, v3
  s_waitcnt lgkmcnt(2)
  v_mfma_f32_32x32x16_bf16 v[64:79], v[100:103], a[40:43], v[64:79]
  ds_read_b64_tr_b16 v[108:109], v187 offset:12288
  ds_read_b64_tr_b16 v[110:111], v187 offset:12800
  s_add_u32 m0, s92, 16384
  s_nop 0
  buffer_load_dwordx4 v132, s[16:19], s64 offen lds
  v_cvt_pk_bf16_f32 v2, v4, v5
  v_mfma_f32_32x32x16_bf16 v[80:95], v[100:103], a[44:47], v[80:95]
  v_cvt_pk_bf16_f32 v3, v6, v7
  s_waitcnt lgkmcnt(2)
  v_mfma_f32_16x16x32_bf16 v[112:115], v[120:123], v[104:107], v[112:115]
  buffer_store_dwordx4 v[0:3], v170, s[20:23], s98 offen offset:0 sc1
  v_mul_f32_e64 v16, v185, v16
  v_mfma_f32_32x32x16_bf16 v[64:79], v[104:107], a[48:51], v[64:79]
  ds_read_b64_tr_b16 v[96:97], v186 offset:16384
  ds_read_b64_tr_b16 v[98:99], v186 offset:16896
  v_mul_f32 v17, v185, v17
  v_mul_f32 v18, v185, v18
  v_mul_f32 v19, v185, v19
  v_mul_f32 v20, v185, v20
  v_mfma_f32_32x32x16_bf16 v[80:95], v[104:107], a[52:55], v[80:95]
  buffer_load_dwordx4 v133, s[16:19], s64 offen offset:1024 lds
  s_add_u32 s64, s64, 221184
  s_cmp_eq_u32 s64, s82
  s_cselect_b32 s64, s93, s64
  v_mul_f32 v21, v185, v21
  s_waitcnt lgkmcnt(2)
  v_mfma_f32_32x32x16_bf16 v[64:79], v[108:111], a[56:59], v[64:79]
  ds_read_b64_tr_b16 v[100:101], v187 offset:16384
  ds_read_b64_tr_b16 v[102:103], v187 offset:16896
  v_mul_f32 v22, v185, v22
  v_mul_f32 v23, v185, v23
  v_cvt_pk_bf16_f32 v16, v16, v17
  v_cvt_pk_bf16_f32 v17, v18, v19
  v_mfma_f32_32x32x16_bf16 v[80:95], v[108:111], a[60:63], v[80:95]
  s_add_u32 m0, s92, 24576
  s_nop 0
  buffer_load_dwordx4 v132, s[16:19], s64 offen lds
  v_cvt_pk_bf16_f32 v18, v20, v21
  v_cvt_pk_bf16_f32 v19, v22, v23
  s_waitcnt lgkmcnt(2)
  v_mfma_f32_16x16x32_bf16 v[112:115], v[120:123], v[96:99], v[112:115]
  v_mfma_f32_32x32x16_bf16 v[64:79], v[96:99], a[64:67], v[64:79]
  ds_read_b64_tr_b16 v[104:105], v186 offset:20480
  ds_read_b64_tr_b16 v[106:107], v186 offset:20992
  buffer_store_dwordx4 v[16:19], v170, s[20:23], s98 offen offset:512 sc1
  s_add_u32 s98, s98, 65536
  v_mul_f32 v8, v184, v8
  v_mul_f32 v9, v184, v9
  v_mfma_f32_32x32x16_bf16 v[80:95], v[96:99], a[68:71], v[80:95]
  v_mul_f32 v10, v184, v10
  v_mul_f32 v11, v184, v11
  v_mul_f32 v12, v184, v12
  v_mul_f32 v13, v184, v13
  v_mul_f32 v14, v184, v14
  s_waitcnt lgkmcnt(2)
  v_mfma_f32_32x32x16_bf16 v[64:79], v[100:103], a[72:75], v[64:79]
  ds_read_b64_tr_b16 v[108:109], v187 offset:20480
  ds_read_b64_tr_b16 v[110:111], v187 offset:20992
  buffer_load_dwordx4 v133, s[16:19], s64 offen offset:1024 lds
  s_add_u32 s64, s64, 221184
  s_cmp_eq_u32 s64, s82
  s_cselect_b32 s64, s93, s64
  v_mfma_f32_32x32x16_bf16 v[80:95], v[100:103], a[76:79], v[80:95]
  v_mul_f32_e64 v15, v184, v15
  v_cvt_pk_bf16_f32 v8, v8, v9
  v_cvt_pk_bf16_f32 v9, v10, v11
  v_cvt_pk_bf16_f32 v10, v12, v13
  v_cvt_pk_bf16_f32 v11, v14, v15
  s_waitcnt lgkmcnt(2)
  v_mfma_f32_16x16x32_bf16 v[112:115], v[120:123], v[104:107], v[112:115]
  buffer_store_dwordx4 v[8:11], v170, s[20:23], s98 offen offset:0 sc1
  v_mul_f32 v24, v185, v24
  v_mfma_f32_32x32x16_bf16 v[64:79], v[104:107], a[80:83], v[64:79]
  ds_read_b64_tr_b16 v[96:97], v186 offset:24576
  ds_read_b64_tr_b16 v[98:99], v186 offset:25088
  v_mul_f32 v25, v185, v25
  v_mul_f32 v26, v185, v26
  v_mul_f32 v27, v185, v27
  v_mul_f32 v28, v185, v28
  v_mfma_f32_32x32x16_bf16 v[80:95], v[104:107], a[84:87], v[80:95]
  s_add_u32 m0, s92, 32768
  s_nop 0
  buffer_load_dwordx4 v132, s[16:19], s64 offen lds
  v_mul_f32 v29, v185, v29
  v_mul_f32 v30, v185, v30
  s_waitcnt lgkmcnt(2)
  v_mfma_f32_32x32x16_bf16 v[64:79], v[108:111], a[88:91], v[64:79]
  ds_read_b64_tr_b16 v[100:101], v187 offset:24576
  ds_read_b64_tr_b16 v[102:103], v187 offset:25088
  v_mul_f32_e64 v31, v185, v31
  v_cvt_pk_bf16_f32 v24, v24, v25
  v_cvt_pk_bf16_f32 v25, v26, v27
  v_cvt_pk_bf16_f32 v26, v28, v29
  v_mfma_f32_32x32x16_bf16 v[80:95], v[108:111], a[92:95], v[80:95]
  buffer_load_dwordx4 v133, s[16:19], s64 offen offset:1024 lds
  s_add_u32 s64, s64, 221184
  s_cmp_eq_u32 s64, s82
  s_cselect_b32 s64, s93, s64
  v_cvt_pk_bf16_f32 v27, v30, v31
  s_waitcnt lgkmcnt(2)
  v_mfma_f32_16x16x32_bf16 v[112:115], v[120:123], v[96:99], v[112:115]
  v_mfma_f32_32x32x16_bf16 v[64:79], v[96:99], a[96:99], v[64:79]
  ds_read_b64_tr_b16 v[104:105], v186 offset:28672
  ds_read_b64_tr_b16 v[106:107], v186 offset:29184
  buffer_store_dwordx4 v[24:27], v170, s[20:23], s98 offen offset:512 sc1
  s_add_u32 s98, s98, 65536
  v_mul_f32 v32, v184, v32
  v_mul_f32_e64 v33, v184, v33
  v_mfma_f32_32x32x16_bf16 v[80:95], v[96:99], a[100:103], v[80:95]
  v_mul_f32 v34, v184, v34
  v_mul_f32 v35, v184, v35
  v_mul_f32 v36, v184, v36
  v_mul_f32 v37, v184, v37
  v_mul_f32 v38, v184, v38
  s_waitcnt lgkmcnt(2)
  v_mfma_f32_32x32x16_bf16 v[64:79], v[100:103], a[104:107], v[64:79]
  ds_read_b64_tr_b16 v[108:109], v187 offset:28672
  ds_read_b64_tr_b16 v[110:111], v187 offset:29184
  s_add_u32 m0, s92, 40960
  s_nop 0
  buffer_load_dwordx4 v132, s[16:19], s64 offen lds
  v_mul_f32 v39, v184, v39
  v_mfma_f32_32x32x16_bf16 v[80:95], v[100:103], a[108:111], v[80:95]
  v_cvt_pk_bf16_f32 v32, v32, v33
  v_cvt_pk_bf16_f32 v33, v34, v35
  v_cvt_pk_bf16_f32 v34, v36, v37
  v_cvt_pk_bf16_f32 v35, v38, v39
  s_waitcnt lgkmcnt(2)
  v_mfma_f32_16x16x32_bf16 v[112:115], v[120:123], v[104:107], v[112:115]
  buffer_load_dwordx4 v133, s[16:19], s64 offen offset:1024 lds
  s_add_u32 s64, s64, 221184
  s_cmp_eq_u32 s64, s82
  s_cselect_b32 s64, s93, s64
  v_mfma_f32_32x32x16_bf16 v[64:79], v[104:107], a[112:115], v[64:79]
  s_waitcnt lgkmcnt(0)
  s_waitcnt vmcnt(17)
  s_barrier
  v_add_u32 v186, 65536, v142
  v_add_u32 v187, 65536, v143
  ds_read_b64_tr_b16 v[96:97], v186 offset:40960
  ds_read_b64_tr_b16 v[98:99], v186 offset:41472
  v_mfma_f32_32x32x16_bf16 v[80:95], v[104:107], a[116:119], v[80:95]
  s_waitcnt vmcnt(16)
  v_cmp_ne_u32 vcc, s77, v189
  s_mov_b32 s97, 0
  s_cbranch_vccz Lpoll_736010_ok
Lpoll_736010:
  s_sleep 1
  buffer_load_dword v189, v188, s[20:23], 0 offen sc1
  s_add_u32 s97, s97, 1
  s_waitcnt vmcnt(0)
  v_cmp_ne_u32 vcc, s77, v189
  s_cmp_gt_u32 s97, 32768
  s_cbranch_scc1 Lpoll_736010_ok
  s_cbranch_vccnz Lpoll_736010
Lpoll_736010_ok:
  buffer_store_dwordx4 v[32:35], v170, s[20:23], s98 offen offset:0 sc1
  v_mfma_f32_32x32x16_bf16 v[64:79], v[108:111], a[120:123], v[64:79]
  ds_read_b64_tr_b16 v[100:101], v187 offset:40960
  ds_read_b64_tr_b16 v[102:103], v187 offset:41472
  v_mul_f32 v48, v185, v48
  v_mul_f32 v49, v185, v49
  v_mul_f32 v50, v185, v50
  v_mul_f32 v51, v185, v51
  v_mfma_f32_32x32x16_bf16 v[80:95], v[108:111], a[124:127], v[80:95]
  s_add_u32 m0, s92, 49152
  s_nop 0
  buffer_load_dwordx4 v132, s[16:19], s64 offen lds
  v_mul_f32 v52, v185, v52
  v_mul_f32 v53, v185, v53
  s_waitcnt lgkmcnt(2)
  v_mfma_f32_16x16x32_bf16 v[112:115], v[120:123], v[96:99], v[112:115]
  v_mul_f32 v54, v185, v54
  v_mul_f32 v55, v185, v55
  v_mfma_f32_32x32x16_bf16 v[64:79], v[96:99], a[128:131], v[64:79]
  ds_read_b64_tr_b16 v[104:105], v186 offset:45056
  ds_read_b64_tr_b16 v[106:107], v186 offset:45568
  v_cvt_pk_bf16_f32 v48, v48, v49
  v_cvt_pk_bf16_f32 v49, v50, v51
  v_cvt_pk_bf16_f32 v50, v52, v53
  v_cvt_pk_bf16_f32 v51, v54, v55
  v_mfma_f32_32x32x16_bf16 v[80:95], v[96:99], a[132:135], v[80:95]
  buffer_store_dwordx4 v[48:51], v170, s[20:23], s98 offen offset:512 sc1
  s_add_u32 s98, s98, 65536
  v_mul_f32 v40, v184, v40
  v_mul_f32 v41, v184, v41
  v_mul_f32 v42, v184, v42
  s_waitcnt lgkmcnt(2)
  v_mfma_f32_32x32x16_bf16 v[64:79], v[100:103], a[136:139], v[64:79]
  ds_read_b64_tr_b16 v[108:109], v187 offset:45056
  ds_read_b64_tr_b16 v[110:111], v187 offset:45568
  v_mul_f32 v43, v184, v43
  v_mul_f32 v44, v184, v44
  v_mul_f32 v45, v184, v45
  v_mul_f32 v46, v184, v46
  v_mfma_f32_32x32x16_bf16 v[80:95], v[100:103], a[140:143], v[80:95]
  buffer_load_dwordx4 v133, s[16:19], s64 offen offset:1024 lds
  s_add_u32 s64, s64, 221184
  s_cmp_eq_u32 s64, s82
  s_cselect_b32 s64, s93, s64
  v_mul_f32 v47, v184, v47
  s_waitcnt lgkmcnt(2)
  v_mfma_f32_16x16x32_bf16 v[112:115], v[120:123], v[104:107], v[112:115]
  v_cvt_pk_bf16_f32 v40, v40, v41
  v_cvt_pk_bf16_f32 v41, v42, v43
  v_mfma_f32_32x32x16_bf16 v[64:79], v[104:107], a[144:147], v[64:79]
  ds_read_b64_tr_b16 v[96:97], v186 offset:49152
  ds_read_b64_tr_b16 v[98:99], v186 offset:49664
  s_add_u32 m0, s92, 90112
  s_nop 0
  buffer_load_dwordx4 v132, s[16:19], s64 offen lds
  v_cvt_pk_bf16_f32 v42, v44, v45
  v_mfma_f32_32x32x16_bf16 v[80:95], v[104:107], a[148:151], v[80:95]
  v_cvt_pk_bf16_f32 v43, v46, v47
  s_waitcnt lgkmcnt(2)
  v_mfma_f32_32x32x16_bf16 v[64:79], v[108:111], a[152:155], v[64:79]
  ds_read_b64_tr_b16 v[100:101], v187 offset:49152
  ds_read_b64_tr_b16 v[102:103], v187 offset:49664
  buffer_store_dwordx4 v[40:43], v170, s[20:23], s98 offen offset:0 sc1
  v_mul_f32 v56, v185, v56
  v_mul_f32 v57, v185, v57
  v_mul_f32_e64 v58, v185, v58
  v_mfma_f32_32x32x16_bf16 v[80:95], v[108:111], a[156:159], v[80:95]
  v_mul_f32 v59, v185, v59
  v_mul_f32 v60, v185, v60
  v_mul_f32 v61, v185, v61
  v_mul_f32 v62, v185, v62
  v_mul_f32 v63, v185, v63
  s_waitcnt lgkmcnt(2)
  v_mfma_f32_16x16x32_bf16 v[112:115], v[120:123], v[96:99], v[112:115]
  buffer_load_dwordx4 v133, s[16:19], s64 offen offset:1024 lds
  s_add_u32 s64, s64, 221184
  s_cmp_eq_u32 s64, s82
  s_cselect_b32 s64, s93, s64
  v_mfma_f32_32x32x16_bf16 v[64:79], v[96:99], a[160:163], v[64:79]
  ds_read_b64_tr_b16 v[104:105], v186 offset:53248
  ds_read_b64_tr_b16 v[106:107], v186 offset:53760
  v_cvt_pk_bf16_f32 v56, v56, v57
  v_cvt_pk_bf16_f32 v57, v58, v59
  v_cvt_pk_bf16_f32 v58, v60, v61
  v_cvt_pk_bf16_f32 v59, v62, v63
  v_mfma_f32_32x32x16_bf16 v[80:95], v[96:99], a[164:167], v[80:95]
  buffer_store_dwordx4 v[56:59], v170, s[20:23], s98 offen offset:512 sc1
  v_and_b32 v177, 31, v190
  v_lshrrev_b32 v179, 5, v190
  v_lshlrev_b32_e64 v178, 2, v179
  v_sub_u32 v178, v177, v178
  s_waitcnt lgkmcnt(2)
  v_mfma_f32_32x32x16_bf16 v[64:79], v[100:103], a[168:171], v[64:79]
  ds_read_b64_tr_b16 v[108:109], v187 offset:53248
  ds_read_b64_tr_b16 v[110:111], v187 offset:53760
  s_mov_b32 s72, 0xf1800000
  v_subrev_u32 v32, 0, v178
  v_ashrrev_i32 v32, 31, v32
  v_and_b32 v32, s72, v32
  v_mfma_f32_32x32x16_bf16 v[80:95], v[100:103], a[172:175], v[80:95]
  s_lshr_b32 m0, s92, 1
  s_add_u32 m0, m0, 58368
  s_add_u32 s4, s52, 2705408
  buffer_load_dwordx4 v171, s[20:23], s4 offen sc1 lds
  v_xor_b32 v48, s72, v32
  s_waitcnt lgkmcnt(2)
  v_mfma_f32_16x16x32_bf16 v[112:115], v[120:123], v[104:107], v[112:115]
  v_subrev_u32_e64 v33, 1, v178
  v_ashrrev_i32 v33, 31, v33
  v_mfma_f32_32x32x16_bf16 v[64:79], v[104:107], a[176:179], v[64:79]
  ds_read_b64_tr_b16 v[96:97], v186 offset:57344
  ds_read_b64_tr_b16 v[98:99], v186 offset:57856
  s_lshr_b32 m0, s92, 1
  s_add_u32 m0, m0, 100352
  s_add_u32 s4, s52, 2706432
  buffer_load_dwordx4 v171, s[20:23], s4 offen sc1 lds
  v_mfma_f32_32x32x16_bf16 v[80:95], v[104:107], a[180:183], v[80:95]
  v_and_b32 v33, s72, v33
  v_xor_b32 v49, s72, v33
  v_subrev_u32 v34, 2, v178
  v_ashrrev_i32 v34, 31, v34
  v_and_b32 v34, s72, v34
  s_waitcnt lgkmcnt(2)
  v_mfma_f32_32x32x16_bf16 v[64:79], v[108:111], a[184:187], v[64:79]
  ds_read_b64_tr_b16 v[100:101], v187 offset:57344
  ds_read_b64_tr_b16 v[102:103], v187 offset:57856
  s_add_u32 m0, s92, 131072
  s_nop 0
  buffer_load_dwordx4 v132, s[16:19], s64 offen lds
  v_xor_b32 v50, s72, v34
  v_mfma_f32_32x32x16_bf16 v[80:95], v[108:111], a[188:191], v[80:95]
  v_subrev_u32 v35, 3, v178
  v_ashrrev_i32 v35, 31, v35
  v_and_b32 v35, s72, v35
  v_xor_b32 v51, s72, v35
  v_subrev_u32 v36, 8, v178
  s_waitcnt lgkmcnt(2)
  v_mfma_f32_16x16x32_bf16 v[112:115], v[120:123], v[96:99], v[112:115]
  buffer_load_dwordx4 v133, s[16:19], s64 offen offset:1024 lds
  s_add_u32 s64, s64, 221184
  s_cmp_eq_u32 s64, s82
  s_cselect_b32 s64, s93, s64
  v_mfma_f32_32x32x16_bf16 v[64:79], v[96:99], a[192:195], v[64:79]
  ds_read_b64_tr_b16 v[104:105], v186 offset:61440
  ds_read_b64_tr_b16 v[106:107], v186 offset:61952
  v_ashrrev_i32 v36, 31, v36
  v_and_b32 v36, s72, v36
  v_xor_b32 v52, s72, v36
  v_subrev_u32 v37, 9, v178
  v_mfma_f32_32x32x16_bf16 v[80:95], v[96:99], a[196:199], v[80:95]
  s_add_u32 m0, s92, 139264
  s_nop 0
  buffer_load_dwordx4 v132, s[16:19], s64 offen lds
  v_ashrrev_i32 v37, 31, v37
  v_and_b32 v37, s72, v37
  s_waitcnt lgkmcnt(2)
  v_mfma_f32_32x32x16_bf16 v[64:79], v[100:103], a[200:203], v[64:79]
  ds_read_b64_tr_b16 v[108:109], v187 offset:61440
  ds_read_b64_tr_b16 v[110:111], v187 offset:61952
  v_xor_b32 v53, s72, v37
  v_subrev_u32 v38, 10, v178
  v_ashrrev_i32 v38, 31, v38
  v_and_b32 v38, s72, v38
  v_mfma_f32_32x32x16_bf16 v[80:95], v[100:103], a[204:207], v[80:95]
  v_xor_b32 v54, s72, v38
  v_subrev_u32 v39, 11, v178
  v_ashrrev_i32 v39, 31, v39
  v_and_b32 v39, s72, v39
  v_xor_b32 v55, s72, v39
  s_waitcnt lgkmcnt(2)
  v_mfma_f32_16x16x32_bf16 v[112:115], v[120:123], v[104:107], v[112:115]
  buffer_load_dwordx4 v133, s[16:19], s64 offen offset:1024 lds
  s_add_u32 s64, s64, 221184
  s_cmp_eq_u32 s64, s82
  s_cselect_b32 s64, s93, s64
  v_mfma_f32_32x32x16_bf16 v[64:79], v[104:107], a[208:211], v[64:79]
  ds_read_b64_tr_b16 v[96:97], v186 offset:0
  ds_read_b64_tr_b16 v[98:99], v186 offset:512
  v_subrev_u32 v40, 16, v178
  v_ashrrev_i32 v40, 31, v40
  v_and_b32 v40, s72, v40
  v_xor_b32 v56, s72, v40
  v_mfma_f32_32x32x16_bf16 v[80:95], v[104:107], a[212:215], v[80:95]
  s_add_u32 m0, s92, 147456
  s_add_u32 s4, s94, 2048000
  buffer_load_dwordx4 v171, s[20:23], s4 offen sc1 lds
  v_subrev_u32_e64 v41, 17, v178
  v_ashrrev_i32 v41, 31, v41
  s_waitcnt lgkmcnt(2)
  v_mfma_f32_32x32x16_bf16 v[64:79], v[108:111], a[216:219], v[64:79]
  ds_read_b64_tr_b16 v[100:101], v187 offset:0
  ds_read_b64_tr_b16 v[102:103], v187 offset:512
  v_and_b32 v41, s72, v41
  v_xor_b32 v57, s72, v41
  v_subrev_u32 v42, 18, v178
  v_ashrrev_i32 v42, 31, v42
  v_mfma_f32_32x32x16_bf16 v[80:95], v[108:111], a[220:223], v[80:95]
  v_and_b32 v42, s72, v42
  v_xor_b32 v58, s72, v42
  v_subrev_u32 v43, 19, v178
  v_ashrrev_i32 v43, 31, v43
  v_and_b32 v43, s72, v43
  s_waitcnt lgkmcnt(2)
  v_mfma_f32_16x16x32_bf16 v[112:115], v[120:123], v[96:99], v[112:115]
  s_add_u32 m0, s92, 148480
  s_add_u32 s4, s94, 2049024
  buffer_load_dwordx4 v171, s[20:23], s4 offen sc1 lds
  v_mfma_f32_32x32x16_bf16 v[64:79], v[96:99], a[224:227], v[64:79]
  ds_read_b64_tr_b16 v[104:105], v186 offset:4096
  ds_read_b64_tr_b16 v[106:107], v186 offset:4608
  v_xor_b32 v59, s72, v43
  v_subrev_u32 v44, 24, v178
  v_ashrrev_i32 v44, 31, v44
  v_and_b32 v44, s72, v44
  v_mfma_f32_32x32x16_bf16 v[80:95], v[96:99], a[228:231], v[80:95]
  s_add_u32 m0, s92, 155648
  s_add_u32 s4, s94, 2050048
  buffer_load_dwordx4 v171, s[20:23], s4 offen sc1 lds
  v_xor_b32_e64 v60, s72, v44
  v_subrev_u32 v45, 25, v178
  s_waitcnt lgkmcnt(2)
  v_mfma_f32_32x32x16_bf16 v[64:79], v[100:103], a[232:235], v[64:79]
  ds_read_b64_tr_b16 v[108:109], v187 offset:4096
  ds_read_b64_tr_b16 v[110:111], v187 offset:4608
  v_ashrrev_i32 v45, 31, v45
  v_and_b32 v45, s72, v45
  v_xor_b32 v61, s72, v45
  v_subrev_u32 v46, 26, v178
  v_mfma_f32_32x32x16_bf16 v[80:95], v[100:103], a[236:239], v[80:95]
  v_ashrrev_i32 v46, 31, v46
  v_and_b32 v46, s72, v46
  v_xor_b32 v62, s72, v46
  v_subrev_u32 v47, 27, v178
  v_ashrrev_i32 v47, 31, v47
  s_waitcnt lgkmcnt(2)
  v_mfma_f32_16x16x32_bf16 v[112:115], v[120:123], v[104:107], v[112:115]
  s_add_u32 m0, s92, 156672
  s_add_u32 s4, s94, 2051072
  buffer_load_dwordx4 v171, s[20:23], s4 offen sc1 lds
  v_mfma_f32_32x32x16_bf16 v[64:79], v[104:107], a[240:243], v[64:79]
  s_waitcnt lgkmcnt(0)
  s_barrier
  ds_read_b64_tr_b16 v[96:97], v186 offset:8192
  ds_read_b64_tr_b16 v[98:99], v186 offset:8704
  v_mfma_f32_32x32x16_bf16 v[80:95], v[104:107], a[244:247], v[80:95]
  s_add_u32 m0, s92, 106496
  s_add_u32 s4, s94, 2052096
  buffer_load_dwordx4 v171, s[20:23], s4 offen sc1 lds
  v_and_b32 v47, s72, v47
  v_xor_b32 v63, s72, v47
  v_mfma_f32_32x32x16_bf16 v[64:79], v[108:111], a[248:251], v[64:79]
  ds_read_b64_tr_b16 v[100:101], v187 offset:8192
  ds_read_b64_tr_b16 v[102:103], v187 offset:8704
  s_and_b32 s70, s84, 1
  s_lshl_b32 s71, s3, 10
  s_add_u32 s72, s71, 0
  v_lshlrev_b32 v177, 4, v177
  v_mfma_f32_32x32x16_bf16 v[80:95], v[108:111], a[252:255], v[80:95]
  v_lshl_add_u32 v138, v179, 13, v177
  v_add_u32 v138, s72, v138
  s_lshl_b32 s72, s70, 3
  s_sub_u32 s69, 32960, s72
  v_mul_u32_u24_e64 v178, s69, v179
  s_waitcnt lgkmcnt(2)
  v_mfma_f32_16x16x32_bf16 v[112:115], v[120:123], v[96:99], v[112:115]
  s_add_u32 s72, s72, s71
  s_add_u32 s72, s72, 16384
  v_mfma_f32_32x32x16_bf16 v[64:79], v[96:99], v[192:195], v[64:79]
  ds_read_b64_tr_b16 v[104:105], v186 offset:12288
  ds_read_b64_tr_b16 v[106:107], v186 offset:12800
  v_add3_u32 v139, v177, v178, s72
  v_bfe_u32 v177, v190, 4, 1
  v_and_b32_e64 v178, 3, v190
  v_lshl_add_u32 v177, v177, 2, v178
  v_mfma_f32_32x32x16_bf16 v[80:95], v[96:99], v[196:199], v[80:95]
  v_add_u32 v178, s70, v177
  v_cmp_lt_u32 vcc, 4, v177
  v_bfe_u32 v177, v190, 2, 2
  v_lshl_add_u32 v179, v179, 2, v177
  v_cndmask_b32_e64 v178, v178, 6, vcc
  s_waitcnt lgkmcnt(2)
  v_mfma_f32_32x32x16_bf16 v[64:79], v[100:103], v[200:203], v[64:79]
  ds_read_b64_tr_b16 v[108:109], v187 offset:12288
  ds_read_b64_tr_b16 v[110:111], v187 offset:12800
  v_lshrrev_b32 v177, 1, v178
  v_mul_u32_u24 v177, 8256, v177
  v_and_b32_e64 v178, 1, v178
  v_lshl_add_u32 v177, v178, 3, v177
  v_mfma_f32_32x32x16_bf16 v[80:95], v[100:103], v[204:207], v[80:95]
  v_lshl_add_u32 v177, v179, 4, v177
  s_add_u32 s72, s71, 24576
  v_add_u32_e64 v140, s72, v177
  s_mov_b32 s28, s56
  s_mov_b32 s29, s57
  s_waitcnt lgkmcnt(2)
  v_mfma_f32_16x16x32_bf16 v[112:115], v[120:123], v[104:107], v[112:115]
  s_mov_b32 s31, 0x20000
  s_or_b32 s72, s85, s60
  v_mfma_f32_32x32x16_bf16 v[64:79], v[104:107], v[208:211], v[64:79]
  ds_read_b64_tr_b16 v[96:97], v186 offset:16384
  ds_read_b64_tr_b16 v[98:99], v186 offset:16896
  s_add_u32 m0, s92, 107520
  s_add_u32 s4, s52, 2211840
  buffer_load_dwordx4 v171, s[20:23], s4 offen sc1 lds
  v_mfma_f32_32x32x16_bf16 v[80:95], v[104:107], v[212:215], v[80:95]
  s_cmp_eq_u32 s72, 0
  s_cselect_b32 s30, 0, 24117248
  s_mul_i32 s5, s84, 5
  s_lshr_b32 s5, s5, 1
  s_lshl_b32 s5, s5, 3
  s_waitcnt lgkmcnt(2)
  v_mfma_f32_32x32x16_bf16 v[64:79], v[108:111], v[216:219], v[64:79]
  ds_read_b64_tr_b16 v[100:101], v187 offset:16384
  ds_read_b64_tr_b16 v[102:103], v187 offset:16896
  s_add_u32 s5, s5, s85
  s_lshl_b32 s5, s5, 12
  s_add_u32 s5, s5, 4194304
  s_mul_i32 s71, s84, 5
  v_mfma_f32_32x32x16_bf16 v[80:95], v[108:111], v[220:223], v[80:95]
  s_lshr_b32 s71, s71, 1
  s_lshl_b32 s72, s85, 2
  s_sub_u32 s72, s72, 4
  v_lshrrev_b32 v177, 3, v190
  v_add_u32 v177, s72, v177
  s_waitcnt lgkmcnt(2)
  v_mfma_f32_16x16x32_bf16 v[112:115], v[120:123], v[96:99], v[112:115]
  s_add_u32 m0, s92, 114688
  s_add_u32 s4, s52, 2212864
  buffer_load_dwordx4 v171, s[20:23], s4 offen sc1 lds
  v_mfma_f32_32x32x16_bf16 v[64:79], v[96:99], v[224:227], v[64:79]
  ds_read_b64_tr_b16 v[104:105], v186 offset:20480
  ds_read_b64_tr_b16 v[106:107], v186 offset:20992
  v_max_i32_e64 v177, 0, v177
  v_bfe_u32 v178, v190, 1, 2
  v_min_u32_e64 v178, 2, v178
  v_mul_u32_u24 v178, 80, v178
  v_mfma_f32_32x32x16_bf16 v[80:95], v[96:99], v[228:231], v[80:95]
  s_add_u32 m0, s92, 115712
  s_add_u32 s4, s52, 2213888
  buffer_load_dwordx4 v171, s[20:23], s4 offen sc1 lds
  v_and_b32 v188, 1, v190
  v_lshl_add_u32 v178, v188, 1, v178
  s_waitcnt lgkmcnt(2)
  v_mfma_f32_32x32x16_bf16 v[64:79], v[100:103], v[232:235], v[64:79]
  ds_read_b64_tr_b16 v[108:109], v187 offset:20480
  ds_read_b64_tr_b16 v[110:111], v187 offset:20992
  v_add_u32 v178, s71, v178
  v_lshrrev_b32 v178, 3, v178
  v_lshl_add_u32 v177, v177, 5, v178
  v_lshlrev_b32_e64 v177, 7, v177
  v_mfma_f32_32x32x16_bf16 v[80:95], v[100:103], v[236:239], v[80:95]
  v_add_u32 v188, 393216, v177
  s_add_u32 m0, s92, 122880
  s_add_u32 s4, s52, 2214912
  buffer_load_dwordx4 v171, s[20:23], s4 offen sc1 lds
  s_add_u32 m0, s92, 123904
  s_add_u32 s4, s52, 2215936
  buffer_load_dwordx4 v171, s[20:23], s4 offen sc1 lds
  s_add_u32 m0, s92, 65536
  s_add_u32 s4, s52, 2375680
  buffer_load_dwordx4 v171, s[20:23], s4 offen sc1 lds
  s_add_u32 m0, s92, 66560
  s_add_u32 s4, s52, 2376704
  buffer_load_dwordx4 v171, s[20:23], s4 offen sc1 lds
  s_waitcnt vmcnt(18)
  s_waitcnt lgkmcnt(2)
  v_mfma_f32_16x16x32_bf16 v[112:115], v[120:123], v[104:107], v[112:115]
  s_add_u32 s100, s41, 393216
  v_mov_b32 v189, s77
  s_mov_b64 exec, 1
  buffer_store_dword v189, off, s[20:23], s100 sc1
  s_mov_b64 exec, -1
  v_mfma_f32_32x32x16_bf16 v[64:79], v[104:107], v[240:243], v[64:79]
  s_lshl_b32 s65, s3, 9
  s_add_u32 s65, s65, 98304
  v_lshl_add_u32 v181, v190, 2, s65
  ds_write_b32 v181, v112 offset:0
  s_waitcnt lgkmcnt(0)
  s_barrier
  v_add_u32 v186, 0, v142
  v_add_u32 v187, 0, v143
  ds_read_b64_tr_b16 v[96:97], v186 offset:0
  ds_read_b64_tr_b16 v[98:99], v186 offset:512
  v_mfma_f32_32x32x16_bf16 v[80:95], v[104:107], v[244:247], v[80:95]
  s_add_u32 m0, s92, 73728
  s_add_u32 s4, s52, 2377728
  buffer_load_dwordx4 v171, s[20:23], s4 offen sc1 lds
  v_mfma_f32_32x32x16_bf16 v[64:79], v[108:111], v[248:251], v[64:79]
  ds_read_b64_tr_b16 v[100:101], v187 offset:0
  ds_read_b64_tr_b16 v[102:103], v187 offset:512
  v_mfma_f32_32x32x16_bf16 v[80:95], v[108:111], v[252:255], v[80:95]
  s_add_u32 m0, s92, 74752
  s_add_u32 s4, s52, 2378752
  buffer_load_dwordx4 v171, s[20:23], s4 offen sc1 lds
  s_waitcnt lgkmcnt(2)
  v_mfma_f32_32x32x16_bf16 v[0:15], v[96:99], a[0:3], 0
  ds_read_b64_tr_b16 v[104:105], v186 offset:4096
  ds_read_b64_tr_b16 v[106:107], v186 offset:4608
  v_and_b32 v181, 4294966783, v181
  ds_read2st64_b32 v[162:163], v181 offset0:0 offset1:2
  s_waitcnt lgkmcnt(0)
  v_add_f32_e64 v182, v162, v163
  v_mfma_f32_16x16x32_bf16 v[112:115], v[120:123], v[96:99], 0
  s_add_u32 m0, s92, 81920
  s_add_u32 s4, s52, 2379776
  buffer_load_dwordx4 v171, s[20:23], s4 offen sc1 lds
  v_mfma_f32_32x32x16_bf16 v[16:31], v[96:99], a[4:7], 0
  v_cvt_pk_bf16_f32 v160, v182, v182
  v_and_b32 v183, 0xffff0000, v160
  v_sub_f32_e64 v182, v182, v183
  v_cvt_pk_bf16_f32 v161, v182, 0
  v_lshl_or_b32 v161, v168, 16, v161
  v_mfma_f32_32x32x16_bf16 v[0:15], v[100:103], a[8:11], v[0:15]
  ds_read_b64_tr_b16 v[108:109], v187 offset:4096
  ds_read_b64_tr_b16 v[110:111], v187 offset:4608
  s_add_u32 m0, s92, 82944
  s_add_u32 s4, s52, 2539520
  buffer_load_dwordx4 v171, s[20:23], s4 offen sc1 lds
  v_mov_b32_e64 v162, v168
  v_mfma_f32_32x32x16_bf16 v[16:31], v[100:103], a[12:15], v[16:31]
  v_mov_b32 v163, 0
  s_nop 1
  v_mfma_f32_32x32x16_bf16 v[64:79], v[160:163], v[144:147], v[64:79]
  v_mfma_f32_32x32x16_bf16 v[80:95], v[160:163], v[152:155], v[80:95]
  s_lshl_b32 s98, s58, 1
  s_add_u32 s98, s98, s60
  s_mul_i32 s98, s98, 216
  s_lshl_b32 s99, s74, 2
  s_add_u32 s98, s98, s99
  s_lshl_b32 s99, s61, 1
  v_mfma_f32_16x16x32_bf16 v[112:115], v[120:123], v[104:107], v[112:115]
  s_add_u32 s4, s94, 0
  buffer_load_dwordx4 a[0:3], v171, s[20:23], s4 offen offset:0 sc1
  v_mfma_f32_32x32x16_bf16 v[0:15], v[104:107], a[16:19], v[0:15]
  ds_read_b64_tr_b16 v[96:97], v186 offset:8192
  ds_read_b64_tr_b16 v[98:99], v186 offset:8704
  s_add_u32 s98, s98, s99
  s_lshl_b32 s98, s98, 10
  s_add_u32 s98, s98, 12582912
  s_mov_b32 s32, s56
  v_mfma_f32_32x32x16_bf16 v[16:31], v[104:107], a[20:23], v[16:31]
  buffer_load_dwordx4 a[4:7], v171, s[20:23], s4 offen offset:1024 sc1
  s_mov_b32 s33, s57
  s_mov_b32 s35, 0x20000
  s_cmp_lt_u32 s74, 27
  s_cselect_b32 s34, 24117248, 0
  s_waitcnt lgkmcnt(2)
  v_mfma_f32_32x32x16_bf16 v[0:15], v[108:111], a[24:27], v[0:15]
  ds_read_b64_tr_b16 v[100:101], v187 offset:8192
  ds_read_b64_tr_b16 v[102:103], v187 offset:8704
  v_mul_f32 v172, v64, v64
  v_mul_f32 v173, v65, v65
  v_mul_f32 v174, v66, v66
  v_mul_f32 v175, v67, v67
  v_mfma_f32_32x32x16_bf16 v[16:31], v[108:111], a[28:31], v[16:31]
  buffer_load_dwordx4 a[8:11], v171, s[20:23], s4 offen offset:2048 sc1
  v_fma_f32 v172, v172, v150, v149
  v_fma_f32 v173, v173, v150, v149
  v_fma_f32 v174, v174, v150, v149
  s_waitcnt lgkmcnt(2)
  v_mfma_f32_16x16x32_bf16 v[112:115], v[120:123], v[96:99], v[112:115]
  v_fma_f32 v175, v175, v150, v149
  v_mul_f32 v172, v172, v64
  v_mfma_f32_32x32x16_bf16 v[0:15], v[96:99], a[32:35], v[0:15]
  ds_read_b64_tr_b16 v[104:105], v186 offset:12288
  ds_read_b64_tr_b16 v[106:107], v186 offset:12800
  buffer_load_dwordx4 a[12:15], v171, s[20:23], s4 offen offset:3072 sc1
  v_mul_f32 v173, v173, v65
  v_mul_f32 v174, v174, v66
  v_mul_f32_e64 v175, v175, v67
  v_mfma_f32_32x32x16_bf16 v[16:31], v[96:99], a[36:39], v[16:31]
  v_exp_f32_e64 v172, v172
  v_exp_f32 v173, v173
  s_waitcnt lgkmcnt(2)
  v_mfma_f32_32x32x16_bf16 v[0:15], v[100:103], a[40:43], v[0:15]
  ds_read_b64_tr_b16 v[108:109], v187 offset:12288
  ds_read_b64_tr_b16 v[110:111], v187 offset:12800
  s_add_u32 s4, s94, 4096
  buffer_load_dwordx4 a[16:19], v171, s[20:23], s4 offen offset:0 sc1
  v_exp_f32_e64 v174, v174
  v_mfma_f32_32x32x16_bf16 v[16:31], v[100:103], a[44:47], v[16:31]
  v_exp_f32 v175, v175
  v_fma_f32 v172, v172, v151, v151
  v_fma_f32 v173, v173, v151, v151
  v_fma_f32 v174, v174, v151, v151
  s_waitcnt lgkmcnt(2)
  v_mfma_f32_16x16x32_bf16 v[112:115], v[120:123], v[104:107], v[112:115]
  s_add_u32 s4, s94, 327680
  buffer_load_dwordx4 a[20:23], v171, s[20:23], s4 offen offset:0 sc1
  v_mfma_f32_32x32x16_bf16 v[0:15], v[104:107], a[48:51], v[0:15]
  ds_read_b64_tr_b16 v[96:97], v186 offset:16384
  ds_read_b64_tr_b16 v[98:99], v186 offset:16896
  v_fma_f32 v175, v175, v151, v151
  v_rcp_f32_e64 v172, v172
  v_mfma_f32_32x32x16_bf16 v[16:31], v[104:107], a[52:55], v[16:31]
  buffer_load_dwordx4 a[24:27], v171, s[20:23], s4 offen offset:1024 sc1
  v_rcp_f32_e64 v173, v173
  v_rcp_f32 v174, v174
  s_waitcnt lgkmcnt(2)
  v_mfma_f32_32x32x16_bf16 v[0:15], v[108:111], a[56:59], v[0:15]
  ds_read_b64_tr_b16 v[100:101], v187 offset:16384
  ds_read_b64_tr_b16 v[102:103], v187 offset:16896
  v_rcp_f32 v175, v175
  v_mul_f32 v64, v172, v64
  v_mul_f32_e64 v65, v173, v65
  v_mfma_f32_32x32x16_bf16 v[16:31], v[108:111], a[60:63], v[16:31]
  v_mul_f32 v66, v174, v66
  v_mul_f32 v67, v175, v67
  v_mul_f32 v172, v68, v68
  v_mul_f32 v173, v69, v69
  v_mul_f32 v174, v70, v70
  s_waitcnt lgkmcnt(2)
  v_mfma_f32_16x16x32_bf16 v[112:115], v[120:123], v[96:99], v[112:115]
  v_mul_f32_e64 v175, v71, v71
  v_fma_f32 v172, v172, v150, v149
  v_mfma_f32_32x32x16_bf16 v[0:15], v[96:99], a[64:67], v[0:15]
  ds_read_b64_tr_b16 v[104:105], v186 offset:20480
  ds_read_b64_tr_b16 v[106:107], v186 offset:20992
  v_fma_f32 v173, v173, v150, v149
  v_fma_f32 v174, v174, v150, v149
  v_fma_f32 v175, v175, v150, v149
  v_mul_f32_e64 v172, v172, v68
  v_mfma_f32_32x32x16_bf16 v[16:31], v[96:99], a[68:71], v[16:31]
  v_mul_f32 v173, v173, v69
  v_mul_f32 v174, v174, v70
  v_mul_f32_e64 v175, v175, v71
  v_exp_f32 v172, v172
  s_waitcnt lgkmcnt(2)
  v_mfma_f32_32x32x16_bf16 v[0:15], v[100:103], a[72:75], v[0:15]
  ds_read_b64_tr_b16 v[108:109], v187 offset:20480
  ds_read_b64_tr_b16 v[110:111], v187 offset:20992
  v_exp_f32 v173, v173
  v_exp_f32 v174, v174
  v_mfma_f32_32x32x16_bf16 v[16:31], v[100:103], a[76:79], v[16:31]
  v_exp_f32 v175, v175
  v_fma_f32 v172, v172, v151, v151
  v_fma_f32 v173, v173, v151, v151
  v_fma_f32 v174, v174, v151, v151
  s_waitcnt lgkmcnt(2)
  v_mfma_f32_16x16x32_bf16 v[112:115], v[120:123], v[104:107], v[112:115]
  v_fma_f32 v175, v175, v151, v151
  v_mfma_f32_32x32x16_bf16 v[0:15], v[104:107], a[80:83], v[0:15]
  ds_read_b64_tr_b16 v[96:97], v186 offset:24576
  ds_read_b64_tr_b16 v[98:99], v186 offset:25088
  v_rcp_f32 v172, v172
  v_rcp_f32 v173, v173
  v_mfma_f32_32x32x16_bf16 v[16:31], v[104:107], a[84:87], v[16:31]
  v_rcp_f32 v174, v174
  v_rcp_f32 v175, v175
  v_mul_f32 v68, v172, v68
  s_waitcnt lgkmcnt(2)
  v_mfma_f32_32x32x16_bf16 v[0:15], v[108:111], a[88:91], v[0:15]
  ds_read_b64_tr_b16 v[100:101], v187 offset:24576
  ds_read_b64_tr_b16 v[102:103], v187 offset:25088
  buffer_load_dwordx4 a[28:31], v171, s[20:23], s4 offen offset:2048 sc1
  v_mul_f32 v69, v173, v69
  v_mul_f32 v70, v174, v70
  v_mul_f32_e64 v71, v175, v71
  v_mfma_f32_32x32x16_bf16 v[16:31], v[108:111], a[92:95], v[16:31]
  v_cvt_pk_bf16_f32 v64, v64, v65
  v_cvt_pk_bf16_f32 v65, v66, v67
  v_cvt_pk_bf16_f32 v66, v68, v69
  v_cvt_pk_bf16_f32 v67, v70, v71
  s_waitcnt lgkmcnt(2)
  v_mfma_f32_16x16x32_bf16 v[112:115], v[120:123], v[96:99], v[112:115]
  buffer_store_dwordx4 v[64:67], v171, s[32:35], s98 offen offset:0 sc1
  v_mul_f32 v172, v72, v72
  v_mfma_f32_32x32x16_bf16 v[0:15], v[96:99], a[96:99], v[0:15]
  ds_read_b64_tr_b16 v[104:105], v186 offset:28672
  ds_read_b64_tr_b16 v[106:107], v186 offset:29184
  v_mul_f32 v173, v73, v73
  v_mul_f32 v174, v74, v74
  v_mul_f32_e64 v175, v75, v75
  v_fma_f32 v172, v172, v150, v149
  v_mfma_f32_32x32x16_bf16 v[16:31], v[96:99], a[100:103], v[16:31]
  buffer_load_dwordx4 a[32:35], v171, s[20:23], s4 offen offset:3072 sc1
  v_fma_f32 v173, v173, v150, v149
  v_fma_f32 v174, v174, v150, v149
  v_fma_f32 v175, v175, v150, v149
  v_mul_f32 v172, v172, v72
  s_waitcnt lgkmcnt(2)
  v_mfma_f32_32x32x16_bf16 v[0:15], v[100:103], a[104:107], v[0:15]
  ds_read_b64_tr_b16 v[108:109], v187 offset:28672
  ds_read_b64_tr_b16 v[110:111], v187 offset:29184
  v_mul_f32 v173, v173, v73
  v_mul_f32 v174, v174, v74
  v_mul_f32_e64 v175, v175, v75
  v_mfma_f32_32x32x16_bf16 v[16:31], v[100:103], a[108:111], v[16:31]
  v_exp_f32 v172, v172
  v_exp_f32 v173, v173
  s_waitcnt lgkmcnt(2)
  v_mfma_f32_16x16x32_bf16 v[112:115], v[120:123], v[104:107], v[112:115]
  s_add_u32 s4, s94, 331776
  buffer_load_dwordx4 a[36:39], v171, s[20:23], s4 offen offset:0 sc1
  v_mfma_f32_32x32x16_bf16 v[0:15], v[104:107], a[112:115], v[0:15]
  s_waitcnt lgkmcnt(0)
  s_waitcnt vmcnt(28)
  s_barrier
  ds_read_b64_tr_b16 v[96:97], v186 offset:32768
  ds_read_b64_tr_b16 v[98:99], v186 offset:33280
  v_mfma_f32_32x32x16_bf16 v[16:31], v[104:107], a[116:119], v[16:31]
  s_add_u32 s4, s94, 655360
  buffer_load_dwordx4 a[40:43], v171, s[20:23], s4 offen offset:0 sc1
  v_exp_f32_e64 v174, v174
  v_mfma_f32_32x32x16_bf16 v[0:15], v[108:111], a[120:123], v[0:15]
  ds_read_b64_tr_b16 v[100:101], v187 offset:32768
  ds_read_b64_tr_b16 v[102:103], v187 offset:33280
  v_exp_f32_e64 v175, v175
  v_fma_f32 v172, v172, v151, v151
  v_fma_f32 v173, v173, v151, v151
  v_mfma_f32_32x32x16_bf16 v[16:31], v[108:111], a[124:127], v[16:31]
  v_fma_f32 v174, v174, v151, v151
  v_fma_f32 v175, v175, v151, v151
  v_rcp_f32 v172, v172
  s_waitcnt lgkmcnt(2)
  v_mfma_f32_16x16x32_bf16 v[112:115], v[120:123], v[96:99], v[112:115]
  buffer_load_dwordx4 a[44:47], v171, s[20:23], s4 offen offset:1024 sc1
  v_mfma_f32_32x32x16_bf16 v[0:15], v[96:99], a[128:131], v[0:15]
  ds_read_b64_tr_b16 v[104:105], v186 offset:36864
  ds_read_b64_tr_b16 v[106:107], v186 offset:37376
  v_rcp_f32 v173, v173
  v_rcp_f32 v174, v174
  v_mfma_f32_32x32x16_bf16 v[16:31], v[96:99], a[132:135], v[16:31]
  v_rcp_f32 v175, v175
  v_mul_f32 v72, v172, v72
  v_mul_f32_e64 v73, v173, v73
  v_mul_f32 v74, v174, v74
  s_waitcnt lgkmcnt(2)
  v_mfma_f32_32x32x16_bf16 v[0:15], v[100:103], a[136:139], v[0:15]
  ds_read_b64_tr_b16 v[108:109], v187 offset:36864
  ds_read_b64_tr_b16 v[110:111], v187 offset:37376
  buffer_load_dwordx4 a[48:51], v171, s[20:23], s4 offen offset:2048 sc1
  v_mul_f32 v75, v175, v75
  v_mul_f32 v172, v76, v76
  v_mul_f32_e64 v173, v77, v77
  v_mfma_f32_32x32x16_bf16 v[16:31], v[100:103], a[140:143], v[16:31]
  v_mul_f32_e64 v174, v78, v78
  v_mul_f32 v175, v79, v79
  v_fma_f32 v172, v172, v150, v149
  s_waitcnt lgkmcnt(2)
  v_mfma_f32_16x16x32_bf16 v[112:115], v[120:123], v[104:107], v[112:115]
  buffer_load_dword v189, v188, s[20:23], 0 offen sc1
  v_fma_f32 v173, v173, v150, v149
  v_mfma_f32_32x32x16_bf16 v[0:15], v[104:107], a[144:147], v[0:15]
  ds_read_b64_tr_b16 v[96:97], v186 offset:40960
  ds_read_b64_tr_b16 v[98:99], v186 offset:41472
  v_fma_f32 v174, v174, v150, v149
  v_fma_f32 v175, v175, v150, v149
  v_mul_f32 v172, v172, v76
  v_mul_f32 v173, v173, v77
  v_mfma_f32_32x32x16_bf16 v[16:31], v[104:107], a[148:151], v[16:31]
  v_mul_f32 v174, v174, v78
  v_mul_f32 v175, v175, v79
  v_exp_f32 v172, v172
  s_waitcnt lgkmcnt(2)
  v_mfma_f32_32x32x16_bf16 v[0:15], v[108:111], a[152:155], v[0:15]
  ds_read_b64_tr_b16 v[100:101], v187 offset:40960
  ds_read_b64_tr_b16 v[102:103], v187 offset:41472
  v_exp_f32 v173, v173
  v_exp_f32 v174, v174
  v_mfma_f32_32x32x16_bf16 v[16:31], v[108:111], a[156:159], v[16:31]
  v_exp_f32 v175, v175
  v_fma_f32 v172, v172, v151, v151
  v_fma_f32 v173, v173, v151, v151
  v_fma_f32 v174, v174, v151, v151
  s_waitcnt lgkmcnt(2)
  v_mfma_f32_16x16x32_bf16 v[112:115], v[120:123], v[96:99], v[112:115]
  buffer_load_dwordx4 a[52:55], v171, s[20:23], s4 offen offset:3072 sc1
  v_fma_f32 v175, v175, v151, v151
  v_mfma_f32_32x32x16_bf16 v[0:15], v[96:99], a[160:163], v[0:15]
  ds_read_b64_tr_b16 v[104:105], v186 offset:45056
  ds_read_b64_tr_b16 v[106:107], v186 offset:45568
  v_rcp_f32 v172, v172
  v_rcp_f32 v173, v173
  v_mfma_f32_32x32x16_bf16 v[16:31], v[96:99], a[164:167], v[16:31]
  v_rcp_f32 v174, v174
  v_rcp_f32 v175, v175
  v_mul_f32 v76, v172, v76
  s_waitcnt lgkmcnt(2)
  v_mfma_f32_32x32x16_bf16 v[0:15], v[100:103], a[168:171], v[0:15]
  ds_read_b64_tr_b16 v[108:109], v187 offset:45056
  ds_read_b64_tr_b16 v[110:111], v187 offset:45568
  s_add_u32 s4, s94, 659456
  buffer_load_dwordx4 a[56:59], v171, s[20:23], s4 offen offset:0 sc1
  v_mul_f32 v77, v173, v77
  v_mul_f32 v78, v174, v78
  v_mfma_f32_32x32x16_bf16 v[16:31], v[100:103], a[172:175], v[16:31]
  v_mul_f32 v79, v175, v79
  v_cvt_pk_bf16_f32 v72, v72, v73
  v_cvt_pk_bf16_f32 v73, v74, v75
  v_cvt_pk_bf16_f32 v74, v76, v77
  v_cvt_pk_bf16_f32 v75, v78, v79
  s_waitcnt lgkmcnt(2)
  v_mfma_f32_16x16x32_bf16 v[112:115], v[120:123], v[104:107], v[112:115]
  buffer_store_dwordx4 v[72:75], v171, s[32:35], s98 offen offset:1024 sc1
  s_add_u32 s98, s98, 110592
  v_mfma_f32_32x32x16_bf16 v[0:15], v[104:107], a[176:179], v[0:15]
  ds_read_b64_tr_b16 v[96:97], v186 offset:49152
  ds_read_b64_tr_b16 v[98:99], v186 offset:49664
  v_mul_f32 v172, v80, v80
  v_mul_f32 v173, v81, v81
  v_mul_f32 v174, v82, v82
  v_mul_f32 v175, v83, v83
  v_mfma_f32_32x32x16_bf16 v[16:31], v[104:107], a[180:183], v[16:31]
  s_add_u32 s4, s94, 983040
  buffer_load_dwordx4 a[60:63], v171, s[20:23], s4 offen offset:0 sc1
  v_fma_f32 v172, v172, v158, v157
  v_fma_f32 v173, v173, v158, v157
  s_waitcnt lgkmcnt(2)
  v_mfma_f32_32x32x16_bf16 v[0:15], v[108:111], a[184:187], v[0:15]
  ds_read_b64_tr_b16 v[100:101], v187 offset:49152
  ds_read_b64_tr_b16 v[102:103], v187 offset:49664
  v_fma_f32 v174, v174, v158, v157
  v_fma_f32 v175, v175, v158, v157
  v_mul_f32 v172, v172, v80
  v_mul_f32_e64 v173, v173, v81
  v_mfma_f32_32x32x16_bf16 v[16:31], v[108:111], a[188:191], v[16:31]
  buffer_load_dwordx4 a[64:67], v171, s[20:23], s4 offen offset:1024 sc1
  v_mul_f32 v174, v174, v82
  v_mul_f32 v175, v175, v83
  v_exp_f32 v172, v172
  s_waitcnt lgkmcnt(2)
  v_mfma_f32_16x16x32_bf16 v[112:115], v[120:123], v[96:99], v[112:115]
  v_exp_f32_e64 v173, v173
  v_mfma_f32_32x32x16_bf16 v[0:15], v[96:99], a[192:195], v[0:15]
  ds_read_b64_tr_b16 v[104:105], v186 offset:53248
  ds_read_b64_tr_b16 v[106:107], v186 offset:53760
  v_exp_f32 v174, v174
  v_exp_f32 v175, v175
  v_mfma_f32_32x32x16_bf16 v[16:31], v[96:99], a[196:199], v[16:31]
  v_fma_f32 v172, v172, v159, v159
  v_fma_f32 v173, v173, v159, v159
  v_fma_f32 v174, v174, v159, v159
  v_fma_f32 v175, v175, v159, v159
  s_waitcnt lgkmcnt(2)
  v_mfma_f32_32x32x16_bf16 v[0:15], v[100:103], a[200:203], v[0:15]
  ds_read_b64_tr_b16 v[108:109], v187 offset:53248
  ds_read_b64_tr_b16 v[110:111], v187 offset:53760
  buffer_load_dwordx4 a[68:71], v171, s[20:23], s4 offen offset:2048 sc1
  v_rcp_f32 v172, v172
  v_mfma_f32_32x32x16_bf16 v[16:31], v[100:103], a[204:207], v[16:31]
  v_rcp_f32_e64 v173, v173
  v_rcp_f32 v174, v174
  s_waitcnt lgkmcnt(2)
  v_mfma_f32_16x16x32_bf16 v[112:115], v[120:123], v[104:107], v[112:115]
  v_rcp_f32_e64 v175, v175
  v_mfma_f32_32x32x16_bf16 v[0:15], v[104:107], a[208:211], v[0:15]
  v_add_u32 v186, 65536, v142
  v_add_u32 v187, 65536, v143
  ds_read_b64_tr_b16 v[96:97], v186 offset:24576
  ds_read_b64_tr_b16 v[98:99], v186 offset:25088
  buffer_load_dwordx4 a[72:75], v171, s[20:23], s4 offen offset:3072 sc1
  v_mul_f32_e64 v80, v172, v80
  v_mfma_f32_32x32x16_bf16 v[16:31], v[104:107], a[212:215], v[16:31]
  v_mul_f32 v81, v173, v81
  v_mul_f32 v82, v174, v82
  v_mul_f32 v83, v175, v83
  v_mul_f32 v172, v84, v84
  v_mul_f32 v173, v85, v85
  s_waitcnt lgkmcnt(2)
  v_mfma_f32_32x32x16_bf16 v[0:15], v[108:111], a[216:219], v[0:15]
  ds_read_b64_tr_b16 v[100:101], v187 offset:24576
  ds_read_b64_tr_b16 v[102:103], v187 offset:25088
  v_mul_f32 v174, v86, v86
  v_mul_f32 v175, v87, v87
  v_fma_f32 v172, v172, v158, v157
  v_fma_f32 v173, v173, v158, v157
  v_mfma_f32_32x32x16_bf16 v[16:31], v[108:111], a[220:223], v[16:31]
  s_add_u32 s4, s94, 987136
  buffer_load_dwordx4 a[76:79], v171, s[20:23], s4 offen offset:0 sc1
  v_fma_f32 v174, v174, v158, v157
  v_fma_f32 v175, v175, v158, v157
  v_mul_f32 v172, v172, v84
  s_waitcnt lgkmcnt(2)
  v_mfma_f32_16x16x32_bf16 v[112:115], v[120:123], v[96:99], v[112:115]
  v_mul_f32 v173, v173, v85
  v_mul_f32 v174, v174, v86
  v_mfma_f32_32x32x16_bf16 v[0:15], v[96:99], a[224:227], v[0:15]
  ds_read_b64_tr_b16 v[104:105], v186 offset:28672
  ds_read_b64_tr_b16 v[106:107], v186 offset:29184
  v_mul_f32 v175, v175, v87
  v_exp_f32 v172, v172
  v_mfma_f32_32x32x16_bf16 v[16:31], v[96:99], a[228:231], v[16:31]
  s_add_u32 s4, s94, 1310720
  buffer_load_dwordx4 a[80:83], v171, s[20:23], s4 offen offset:0 sc1
  v_exp_f32 v173, v173
  s_waitcnt lgkmcnt(2)
  v_mfma_f32_32x32x16_bf16 v[0:15], v[100:103], a[232:235], v[0:15]
  ds_read_b64_tr_b16 v[108:109], v187 offset:28672
  ds_read_b64_tr_b16 v[110:111], v187 offset:29184
  v_exp_f32 v174, v174
  v_exp_f32 v175, v175
  v_mfma_f32_32x32x16_bf16 v[16:31], v[100:103], a[236:239], v[16:31]
  buffer_load_dwordx4 a[84:87], v171, s[20:23], s4 offen offset:1024 sc1
  buffer_load_dwordx4 a[88:91], v171, s[20:23], s4 offen offset:2048 sc1
  buffer_load_dwordx4 a[92:95], v171, s[20:23], s4 offen offset:3072 sc1
  s_waitcnt vmcnt(12)
  v_cmp_ne_u32_e64 vcc, s77, v189
  s_mov_b32 s97, 0
  s_cbranch_vccz Lpoll_743011_ok
Lpoll_743011:
  s_sleep 1
  buffer_load_dword v189, v188, s[20:23], 0 offen sc1
  s_add_u32 s97, s97, 1
  s_waitcnt vmcnt(0)
  v_cmp_ne_u32 vcc, s77, v189
  s_cmp_gt_u32 s97, 32768
  s_cbranch_scc1 Lpoll_743011_ok
  s_cbranch_vccnz Lpoll_743011
Lpoll_743011_ok:
  s_waitcnt lgkmcnt(2)
  v_mfma_f32_16x16x32_bf16 v[112:115], v[120:123], v[104:107], v[112:115]
  v_fma_f32 v172, v172, v159, v159
  v_fma_f32 v173, v173, v159, v159
  v_mfma_f32_32x32x16_bf16 v[0:15], v[104:107], a[240:243], v[0:15]
  s_waitcnt lgkmcnt(0)
  s_barrier
  v_add_u32 v186, 131072, v142
  v_add_u32 v187, 131072, v143
  ds_read_b64_tr_b16 v[96:97], v186 offset:0
  ds_read_b64_tr_b16 v[98:99], v186 offset:512
  v_mfma_f32_32x32x16_bf16 v[16:31], v[104:107], a[244:247], v[16:31]
  v_fma_f32 v174, v174, v159, v159
  v_fma_f32 v175, v175, v159, v159
  v_rcp_f32_e64 v172, v172
  v_mfma_f32_32x32x16_bf16 v[0:15], v[108:111], a[248:251], v[0:15]
  ds_read_b64_tr_b16 v[100:101], v187 offset:0
  ds_read_b64_tr_b16 v[102:103], v187 offset:512
  v_rcp_f32 v173, v173
  v_rcp_f32 v174, v174
  v_mfma_f32_32x32x16_bf16 v[16:31], v[108:111], a[252:255], v[16:31]
  v_rcp_f32 v175, v175
  v_mul_f32 v84, v172, v84
  v_mul_f32_e64 v85, v173, v85
  v_mul_f32 v86, v174, v86
  s_waitcnt lgkmcnt(2)
  v_mfma_f32_16x16x32_bf16 v[112:115], v[120:123], v[96:99], v[112:115]
  v_mul_f32_e64 v87, v175, v87
  v_cvt_pk_bf16_f32 v80, v80, v81
  v_mfma_f32_32x32x16_bf16 v[0:15], v[96:99], v[192:195], v[0:15]
  ds_read_b64_tr_b16 v[104:105], v186 offset:4096
  ds_read_b64_tr_b16 v[106:107], v186 offset:4608
  v_cvt_pk_bf16_f32 v81, v82, v83
  v_cvt_pk_bf16_f32 v82, v84, v85
  v_cvt_pk_bf16_f32 v83, v86, v87
  buffer_store_dwordx4 v[80:83], v171, s[32:35], s98 offen offset:0 sc1
  v_mfma_f32_32x32x16_bf16 v[16:31], v[96:99], v[196:199], v[16:31]
  v_mul_f32 v172, v88, v88
  v_mul_f32 v173, v89, v89
  v_mul_f32_e64 v174, v90, v90
  v_mul_f32 v175, v91, v91
  v_fma_f32 v172, v172, v158, v157
  s_waitcnt lgkmcnt(2)
  v_mfma_f32_32x32x16_bf16 v[0:15], v[100:103], v[200:203], v[0:15]
  ds_read_b64_tr_b16 v[108:109], v187 offset:4096
  ds_read_b64_tr_b16 v[110:111], v187 offset:4608
  v_fma_f32 v173, v173, v158, v157
  v_fma_f32 v174, v174, v158, v157
  v_fma_f32 v175, v175, v158, v157
  v_mul_f32_e64 v172, v172, v88
  v_mfma_f32_32x32x16_bf16 v[16:31], v[100:103], v[204:207], v[16:31]
  v_mul_f32 v173, v173, v89
  v_mul_f32 v174, v174, v90
  v_mul_f32_e64 v175, v175, v91
  v_exp_f32 v172, v172
  s_waitcnt lgkmcnt(2)
  v_mfma_f32_16x16x32_bf16 v[112:115], v[120:123], v[104:107], v[112:115]
  v_exp_f32_e64 v173, v173
  v_mfma_f32_32x32x16_bf16 v[0:15], v[104:107], v[208:211], v[0:15]
  ds_read_b64_tr_b16 v[96:97], v186 offset:8192
  ds_read_b64_tr_b16 v[98:99], v186 offset:8704
  v_exp_f32 v174, v174
  v_exp_f32 v175, v175
  v_mfma_f32_32x32x16_bf16 v[16:31], v[104:107], v[212:215], v[16:31]
  v_fma_f32 v172, v172, v159, v159
  v_fma_f32 v173, v173, v159, v159
  v_fma_f32 v174, v174, v159, v159
  v_fma_f32 v175, v175, v159, v159
  s_waitcnt lgkmcnt(2)
  v_mfma_f32_32x32x16_bf16 v[0:15], v[108:111], v[216:219], v[0:15]
  ds_read_b64_tr_b16 v[100:101], v187 offset:8192
  ds_read_b64_tr_b16 v[102:103], v187 offset:8704
  v_rcp_f32 v172, v172
  v_rcp_f32_e64 v173, v173
  v_mfma_f32_32x32x16_bf16 v[16:31], v[108:111], v[220:223], v[16:31]
  v_rcp_f32 v174, v174
  v_rcp_f32 v175, v175
  v_mul_f32 v88, v172, v88
  s_waitcnt lgkmcnt(2)
  v_mfma_f32_16x16x32_bf16 v[112:115], v[120:123], v[96:99], v[112:115]
  v_mul_f32 v89, v173, v89
  v_mul_f32 v90, v174, v90
  v_mfma_f32_32x32x16_bf16 v[0:15], v[96:99], v[224:227], v[0:15]
  ds_read_b64_tr_b16 v[104:105], v186 offset:12288
  ds_read_b64_tr_b16 v[106:107], v186 offset:12800
  v_mul_f32 v91, v175, v91
  v_mul_f32 v172, v92, v92
  v_mul_f32 v173, v93, v93
  v_mul_f32 v174, v94, v94
  v_mfma_f32_32x32x16_bf16 v[16:31], v[96:99], v[228:231], v[16:31]
  v_mul_f32_e64 v175, v95, v95
  v_fma_f32 v172, v172, v158, v157
  v_fma_f32 v173, v173, v158, v157
  v_fma_f32 v174, v174, v158, v157
  v_fma_f32 v175, v175, v158, v157
  s_waitcnt lgkmcnt(2)
  v_mfma_f32_32x32x16_bf16 v[0:15], v[100:103], v[232:235], v[0:15]
  ds_read_b64_tr_b16 v[108:109], v187 offset:12288
  ds_read_b64_tr_b16 v[110:111], v187 offset:12800
  v_mul_f32 v172, v172, v92
  v_mul_f32 v173, v173, v93
  v_mul_f32 v174, v174, v94
  v_mul_f32_e64 v175, v175, v95
  v_mfma_f32_32x32x16_bf16 v[16:31], v[100:103], v[236:239], v[16:31]
  v_exp_f32_e64 v172, v172
  v_exp_f32 v173, v173
  s_waitcnt lgkmcnt(2)
  v_mfma_f32_16x16x32_bf16 v[112:115], v[120:123], v[104:107], v[112:115]
  v_exp_f32_e64 v174, v174
  v_mfma_f32_32x32x16_bf16 v[0:15], v[104:107], v[240:243], v[0:15]
  s_lshl_b32 s65, s3, 9
  s_add_u32 s65, s65, 98304
  v_lshl_add_u32 v181, v190, 2, s65
  s_nop 2
  ds_write_b32 v181, v112 offset:0
  s_waitcnt lgkmcnt(0)
  s_barrier
  v_mfma_f32_32x32x16_bf16 v[16:31], v[104:107], v[244:247], v[16:31]
  v_exp_f32_e64 v175, v175
  v_fma_f32 v172, v172, v159, v159
  v_fma_f32 v173, v173, v159, v159
  v_fma_f32 v174, v174, v159, v159
  v_mfma_f32_32x32x16_bf16 v[0:15], v[108:111], v[248:251], v[0:15]
  v_and_b32 v181, 4294966783, v181
  ds_read2st64_b32 v[166:167], v181 offset0:0 offset1:2
  v_fma_f32 v175, v175, v159, v159
  v_rcp_f32_e64 v172, v172
  v_mfma_f32_32x32x16_bf16 v[16:31], v[108:111], v[252:255], v[16:31]
  v_rcp_f32 v173, v173
  v_rcp_f32 v174, v174
  v_rcp_f32 v175, v175
  v_mul_f32 v92, v172, v92
  s_and_b32 s6, s84, 1
  s_add_u32 s6, s6, s61
  s_add_u32 s6, s6, 80
  s_lshl_b32 s7, s61, 13
  s_add_u32 s7, s7, 0
  s_lshl_b32 s6, s6, 3
  s_add_u32 s6, s6, s60
  s_sub_u32 s6, s6, 1
  s_lshl_b32 s6, s6, 12
  s_add_u32 s6, s6, s5
  s_lshl_b32 m0, s60, 12
  s_add_u32 m0, m0, s7
  s_nop 0
  buffer_load_dwordx4 v171, s[28:31], s6 offen offset:0 sc1 lds
  v_mul_f32 v93, v173, v93
  v_mul_f32 v94, v174, v94
  v_mul_f32_e64 v95, v175, v95
  v_cvt_pk_bf16_f32 v88, v88, v89
  v_cvt_pk_bf16_f32 v89, v90, v91
  v_cvt_pk_bf16_f32 v90, v92, v93
  v_cvt_pk_bf16_f32 v91, v94, v95
  buffer_store_dwordx4 v[88:91], v171, s[32:35], s98 offen offset:1024 sc1
  s_waitcnt lgkmcnt(0)
  v_add_f32 v182, v166, v167
  v_cvt_pk_bf16_f32 v164, v182, v182
  v_and_b32 v183, 0xffff0000, v164
  v_sub_f32_e64 v182, v182, v183
  v_cvt_pk_bf16_f32 v165, v182, 0
  v_lshl_or_b32 v165, v169, 16, v165
  v_mov_b32_e64 v166, v169
  v_mov_b32 v167, 0
  buffer_load_dwordx4 v171, s[28:31], s6 offen offset:1024 sc1 lds
  s_nop 0
  v_mfma_f32_32x32x16_bf16 v[0:15], v[164:167], v[144:147], v[0:15]
  v_mfma_f32_32x32x16_bf16 v[16:31], v[164:167], v[152:155], v[16:31]
  buffer_load_dwordx4 v171, s[28:31], s6 offen offset:2048 sc1 lds
  s_or_b32 s69, s85, s61
  s_cmp_eq_u32 s69, 0
  s_cselect_b32 s69, 0, 0x3f803f80
  v_mov_b32 v182, s69
  v_mov_b32 v183, s69
  v_mov_b32_e64 v184, s69
  v_mov_b32 v185, s69
  s_lshl_b32 s69, s3, 11
  s_add_u32 s69, s69, 49344
  v_add_u32 v180, s69, v171
  buffer_load_dwordx4 v171, s[28:31], s6 offen offset:3072 sc1 lds
  ds_write_b128 v180, v[182:185]
  ds_write_b128 v180, v[182:185] offset:1024
  s_lshl_b32 s98, s58, 1
  s_add_u32 s98, s98, s60
  s_mul_i32 s98, s98, 216
  s_lshl_b32 s99, s75, 2
  s_add_u32 s98, s98, s99
  s_lshl_b32 s99, s61, 1
  s_add_u32 s98, s98, s99
  s_lshl_b32 s98, s98, 10
  s_add_u32 s98, s98, 12582912
  s_mov_b32 s32, s56
  s_mov_b32 s33, s57
  s_mov_b32 s35, 0x20000
  s_cmp_lt_u32 s75, 27
  s_cselect_b32 s34, 24117248, 0
  v_pk_mul_f32 v[172:173], v[0:1], v[0:1]
  s_and_b32 s6, s84, 1
  s_lshl_b32 s6, s6, 1
  s_sub_u32 s6, 82, s6
  s_mov_b32 s7, 24576
  s_cmp_eq_u32 s61, 0
  s_cselect_b32 s6, s6, 160
  s_cselect_b32 s7, 16384, s7
  s_lshl_b32 s6, s6, 3
  s_add_u32 s6, s6, s60
  s_sub_u32 s6, s6, 1
  s_lshl_b32 s6, s6, 12
  s_add_u32 s6, s6, s5
  s_lshl_b32 m0, s60, 12
  s_add_u32 m0, m0, s7
  s_nop 0
  buffer_load_dwordx4 v171, s[28:31], s6 offen offset:0 sc1 lds
  v_pk_mul_f32 v[174:175], v[2:3], v[2:3]
  v_pk_mul_f32 v[176:177], v[4:5], v[4:5]
  v_pk_mul_f32 v[178:179], v[6:7], v[6:7]
  v_pk_fma_f32 v[172:173], v[172:173], v[150:151], v[148:149] op_sel:[0,0,1] op_sel_hi:[1,0,1]
  v_pk_fma_f32 v[174:175], v[174:175], v[150:151], v[148:149] op_sel:[0,0,1] op_sel_hi:[1,0,1]
  v_pk_fma_f32 v[176:177], v[176:177], v[150:151], v[148:149] op_sel:[0,0,1] op_sel_hi:[1,0,1]
  v_pk_fma_f32 v[178:179], v[178:179], v[150:151], v[148:149] op_sel:[0,0,1] op_sel_hi:[1,0,1]
  v_pk_mul_f32 v[172:173], v[172:173], v[0:1]
  v_pk_mul_f32 v[174:175], v[174:175], v[2:3]
  v_pk_mul_f32 v[176:177], v[176:177], v[4:5]
  buffer_load_dwordx4 v171, s[28:31], s6 offen offset:1024 sc1 lds
  v_pk_mul_f32 v[178:179], v[178:179], v[6:7]
  v_exp_f32 v172, v172
  v_exp_f32 v173, v173
  v_exp_f32 v174, v174
  v_exp_f32 v175, v175
  v_exp_f32_e64 v176, v176
  buffer_load_dwordx4 v171, s[28:31], s6 offen offset:2048 sc1 lds
  v_exp_f32 v177, v177
  v_exp_f32 v178, v178
  v_exp_f32_e64 v179, v179
  v_pk_fma_f32 v[172:173], v[172:173], v[150:151], v[150:151] op_sel:[0,1,1] op_sel_hi:[1,1,1]
  v_pk_fma_f32 v[174:175], v[174:175], v[150:151], v[150:151] op_sel:[0,1,1] op_sel_hi:[1,1,1]
  v_pk_fma_f32 v[176:177], v[176:177], v[150:151], v[150:151] op_sel:[0,1,1] op_sel_hi:[1,1,1]
  v_pk_fma_f32 v[178:179], v[178:179], v[150:151], v[150:151] op_sel:[0,1,1] op_sel_hi:[1,1,1]
  buffer_load_dwordx4 v171, s[28:31], s6 offen offset:3072 sc1 lds
  v_rcp_f32 v172, v172
  v_rcp_f32 v173, v173
  v_rcp_f32 v174, v174
  v_rcp_f32 v175, v175
  v_rcp_f32_e64 v176, v176
  s_add_u32 s6, s61, 161
  s_mul_i32 s7, s61, 8256
  s_add_u32 s7, s7, 32832
  s_lshl_b32 s6, s6, 3
  s_add_u32 s6, s6, s60
  s_sub_u32 s6, s6, 1
  s_lshl_b32 s6, s6, 12
  s_add_u32 s6, s6, s5
  s_lshl_b32 m0, s60, 12
  s_add_u32 m0, m0, s7
  s_nop 0
  buffer_load_dwordx4 v171, s[28:31], s6 offen offset:0 sc1 lds
  v_rcp_f32 v177, v177
  v_rcp_f32 v178, v178
  v_rcp_f32_e64 v179, v179
  v_pk_mul_f32 v[0:1], v[172:173], v[0:1]
  v_pk_mul_f32 v[2:3], v[174:175], v[2:3]
  v_pk_mul_f32 v[4:5], v[176:177], v[4:5]
  v_pk_mul_f32 v[6:7], v[178:179], v[6:7]
  buffer_load_dwordx4 v171, s[28:31], s6 offen offset:1024 sc1 lds
  v_cvt_pk_bf16_f32 v0, v0, v1
  v_cvt_pk_bf16_f32 v1, v2, v3
  v_cvt_pk_bf16_f32 v2, v4, v5
  v_cvt_pk_bf16_f32 v3, v6, v7
  buffer_store_dwordx4 v[0:3], v171, s[32:35], s98 offen offset:0 sc1
  v_pk_mul_f32 v[172:173], v[8:9], v[8:9]
  v_pk_mul_f32 v[174:175], v[10:11], v[10:11]
  v_pk_mul_f32 v[176:177], v[12:13], v[12:13]
  v_pk_mul_f32 v[178:179], v[14:15], v[14:15]
  v_pk_fma_f32 v[172:173], v[172:173], v[150:151], v[148:149] op_sel:[0,0,1] op_sel_hi:[1,0,1]
  v_pk_fma_f32 v[174:175], v[174:175], v[150:151], v[148:149] op_sel:[0,0,1] op_sel_hi:[1,0,1]
  v_pk_fma_f32 v[176:177], v[176:177], v[150:151], v[148:149] op_sel:[0,0,1] op_sel_hi:[1,0,1]
  v_pk_fma_f32 v[178:179], v[178:179], v[150:151], v[148:149] op_sel:[0,0,1] op_sel_hi:[1,0,1]
  v_pk_mul_f32 v[172:173], v[172:173], v[8:9]
  v_pk_mul_f32 v[174:175], v[174:175], v[10:11]
  buffer_load_dwordx4 v171, s[28:31], s6 offen offset:2048 sc1 lds
  v_pk_mul_f32 v[176:177], v[176:177], v[12:13]
  v_pk_mul_f32 v[178:179], v[178:179], v[14:15]
  v_exp_f32 v172, v172
  v_exp_f32 v173, v173
  v_exp_f32 v174, v174
  v_exp_f32 v175, v175
  v_exp_f32 v176, v176
  v_exp_f32 v177, v177
  v_exp_f32 v178, v178
  v_exp_f32 v179, v179
  v_pk_fma_f32 v[172:173], v[172:173], v[150:151], v[150:151] op_sel:[0,1,1] op_sel_hi:[1,1,1]
  v_pk_fma_f32 v[174:175], v[174:175], v[150:151], v[150:151] op_sel:[0,1,1] op_sel_hi:[1,1,1]
  v_pk_fma_f32 v[176:177], v[176:177], v[150:151], v[150:151] op_sel:[0,1,1] op_sel_hi:[1,1,1]
  v_pk_fma_f32 v[178:179], v[178:179], v[150:151], v[150:151] op_sel:[0,1,1] op_sel_hi:[1,1,1]
  v_rcp_f32 v172, v172
  v_rcp_f32 v173, v173
  v_rcp_f32 v174, v174
  v_rcp_f32 v175, v175
  v_rcp_f32 v176, v176
  v_rcp_f32 v177, v177
  v_rcp_f32 v178, v178
  v_rcp_f32 v179, v179
  v_pk_mul_f32 v[8:9], v[172:173], v[8:9]
  v_pk_mul_f32 v[10:11], v[174:175], v[10:11]
  v_pk_mul_f32 v[12:13], v[176:177], v[12:13]
  v_pk_mul_f32 v[14:15], v[178:179], v[14:15]
  v_cvt_pk_bf16_f32 v8, v8, v9
  v_cvt_pk_bf16_f32 v9, v10, v11
  v_cvt_pk_bf16_f32 v10, v12, v13
  v_cvt_pk_bf16_f32 v11, v14, v15
  buffer_store_dwordx4 v[8:11], v171, s[32:35], s98 offen offset:1024 sc1
  s_add_u32 s98, s98, 110592
  v_pk_mul_f32 v[172:173], v[16:17], v[16:17]
  v_pk_mul_f32 v[174:175], v[18:19], v[18:19]
  v_pk_mul_f32 v[176:177], v[20:21], v[20:21]
  v_pk_mul_f32 v[178:179], v[22:23], v[22:23]
  v_pk_fma_f32 v[172:173], v[172:173], v[158:159], v[156:157] op_sel:[0,0,1] op_sel_hi:[1,0,1]
  v_pk_fma_f32 v[174:175], v[174:175], v[158:159], v[156:157] op_sel:[0,0,1] op_sel_hi:[1,0,1]
  v_pk_fma_f32 v[176:177], v[176:177], v[158:159], v[156:157] op_sel:[0,0,1] op_sel_hi:[1,0,1]
  v_pk_fma_f32 v[178:179], v[178:179], v[158:159], v[156:157] op_sel:[0,0,1] op_sel_hi:[1,0,1]
  v_pk_mul_f32 v[172:173], v[172:173], v[16:17]
  v_pk_mul_f32 v[174:175], v[174:175], v[18:19]
  buffer_load_dwordx4 v171, s[28:31], s6 offen offset:3072 sc1 lds
  s_and_b32 s7, s84, 1
  s_lshl_b32 s6, s3, 10
  s_add_u32 s5, s5, s6
  s_lshl_b32 s6, s7, 15
  s_add_u32 s6, s6, s5
  v_and_b32 v141, 32, v190
  v_lshl_add_u32 v141, v141, 25, v170
  v_lshl_add_u32 v141, s7, 3, v141
  s_xor_b32 s7, s7, 1
  s_lshl_b32 s7, s7, 16
  s_add_u32 s5, s5, s7
  buffer_load_dwordx4 v[124:127], v170, s[20:23], s6 offen offset:0 sc1
  buffer_load_dwordx2 v[128:129], v141, s[20:23], s5 offen offset:0 sc1
  s_waitcnt vmcnt(15)
  s_add_u32 s100, s41, 131072
  v_mov_b32_e64 v189, s77
  s_mov_b64 exec, 1
  buffer_store_dword v189, off, s[20:23], s100 sc1
  s_mov_b64 exec, -1
  v_pk_mul_f32 v[176:177], v[176:177], v[20:21]
  v_pk_mul_f32 v[178:179], v[178:179], v[22:23]
  v_exp_f32 v172, v172
  v_exp_f32 v173, v173
  v_exp_f32 v174, v174
  v_exp_f32 v175, v175
  v_exp_f32 v176, v176
  v_exp_f32 v177, v177
  v_exp_f32 v178, v178
  v_exp_f32 v179, v179
  v_pk_fma_f32 v[172:173], v[172:173], v[158:159], v[158:159] op_sel:[0,1,1] op_sel_hi:[1,1,1]
  v_pk_fma_f32 v[174:175], v[174:175], v[158:159], v[158:159] op_sel:[0,1,1] op_sel_hi:[1,1,1]
  v_pk_fma_f32 v[176:177], v[176:177], v[158:159], v[158:159] op_sel:[0,1,1] op_sel_hi:[1,1,1]
  v_pk_fma_f32 v[178:179], v[178:179], v[158:159], v[158:159] op_sel:[0,1,1] op_sel_hi:[1,1,1]
  v_rcp_f32 v172, v172
  v_rcp_f32 v173, v173
  v_rcp_f32 v174, v174
  v_rcp_f32 v175, v175
  v_rcp_f32 v176, v176
  v_rcp_f32 v177, v177
  v_rcp_f32 v178, v178
  v_rcp_f32 v179, v179
  v_pk_mul_f32 v[16:17], v[172:173], v[16:17]
  buffer_load_dwordx4 v[134:137], v170, s[20:23], s6 offen offset:512 sc1
  buffer_load_dwordx2 v[130:131], v141, s[20:23], s5 offen offset:512 sc1
  v_pk_mul_f32 v[18:19], v[174:175], v[18:19]
  v_pk_mul_f32 v[20:21], v[176:177], v[20:21]
  v_pk_mul_f32 v[22:23], v[178:179], v[22:23]
  v_cvt_pk_bf16_f32 v16, v16, v17
  v_cvt_pk_bf16_f32 v17, v18, v19
  v_cvt_pk_bf16_f32 v18, v20, v21
  v_cvt_pk_bf16_f32 v19, v22, v23
  buffer_store_dwordx4 v[16:19], v171, s[32:35], s98 offen offset:0 sc1
  v_pk_mul_f32 v[172:173], v[24:25], v[24:25]
  v_pk_mul_f32 v[174:175], v[26:27], v[26:27]
  v_pk_mul_f32 v[176:177], v[28:29], v[28:29]
  v_pk_mul_f32 v[178:179], v[30:31], v[30:31]
  v_pk_fma_f32 v[172:173], v[172:173], v[158:159], v[156:157] op_sel:[0,0,1] op_sel_hi:[1,0,1]
  v_pk_fma_f32 v[174:175], v[174:175], v[158:159], v[156:157] op_sel:[0,0,1] op_sel_hi:[1,0,1]
  v_pk_fma_f32 v[176:177], v[176:177], v[158:159], v[156:157] op_sel:[0,0,1] op_sel_hi:[1,0,1]
  v_pk_fma_f32 v[178:179], v[178:179], v[158:159], v[156:157] op_sel:[0,0,1] op_sel_hi:[1,0,1]
  v_pk_mul_f32 v[172:173], v[172:173], v[24:25]
  v_pk_mul_f32 v[174:175], v[174:175], v[26:27]
  v_pk_mul_f32 v[176:177], v[176:177], v[28:29]
  v_pk_mul_f32 v[178:179], v[178:179], v[30:31]
  v_exp_f32 v172, v172
  v_exp_f32 v173, v173
  v_exp_f32 v174, v174
  v_exp_f32 v175, v175
  v_exp_f32 v176, v176
  v_exp_f32 v177, v177
  v_exp_f32 v178, v178
  v_exp_f32 v179, v179
  v_pk_fma_f32 v[172:173], v[172:173], v[158:159], v[158:159] op_sel:[0,1,1] op_sel_hi:[1,1,1]
  v_pk_fma_f32 v[174:175], v[174:175], v[158:159], v[158:159] op_sel:[0,1,1] op_sel_hi:[1,1,1]
  v_pk_fma_f32 v[176:177], v[176:177], v[158:159], v[158:159] op_sel:[0,1,1] op_sel_hi:[1,1,1]
  v_pk_fma_f32 v[178:179], v[178:179], v[158:159], v[158:159] op_sel:[0,1,1] op_sel_hi:[1,1,1]
  v_rcp_f32 v172, v172
  v_rcp_f32 v173, v173
  s_add_u32 s4, s94, 1314816
  buffer_load_dwordx4 a[96:99], v171, s[20:23], s4 offen offset:0 sc1
  v_rcp_f32 v174, v174
  v_rcp_f32 v175, v175
  v_rcp_f32 v176, v176
  v_rcp_f32 v177, v177
  v_rcp_f32 v178, v178
  v_rcp_f32 v179, v179
  v_pk_mul_f32 v[24:25], v[172:173], v[24:25]
  v_pk_mul_f32 v[26:27], v[174:175], v[26:27]
  v_pk_mul_f32 v[28:29], v[176:177], v[28:29]
  v_pk_mul_f32 v[30:31], v[178:179], v[30:31]
  v_cvt_pk_bf16_f32 v24, v24, v25
  v_cvt_pk_bf16_f32 v25, v26, v27
  v_cvt_pk_bf16_f32 v26, v28, v29
  v_cvt_pk_bf16_f32 v27, v30, v31
  buffer_store_dwordx4 v[24:27], v171, s[32:35], s98 offen offset:1024 sc1
  s_add_u32 s4, s94, 1638400
  buffer_load_dwordx4 a[100:103], v171, s[20:23], s4 offen offset:0 sc1
  buffer_load_dwordx4 a[104:107], v171, s[20:23], s4 offen offset:1024 sc1
  buffer_load_dwordx4 a[108:111], v171, s[20:23], s4 offen offset:2048 sc1
  buffer_load_dwordx4 a[112:115], v171, s[20:23], s4 offen offset:3072 sc1
  s_add_u32 s4, s94, 1642496
  buffer_load_dwordx4 a[116:119], v171, s[20:23], s4 offen offset:0 sc1
  s_add_u32 s4, s94, 1966080
  buffer_load_dwordx4 a[120:123], v171, s[20:23], s4 offen offset:0 sc1
  buffer_load_dwordx4 a[124:127], v171, s[20:23], s4 offen offset:1024 sc1
  s_waitcnt vmcnt(15)
  s_waitcnt lgkmcnt(0)
  s_barrier
  ds_read_b128 v[144:147], v138 offset:0
  ds_read_b64 v[148:149], v139 offset:0
  ds_read_b128 v[150:153], v138 offset:512
  ds_read_b64 v[154:155], v139 offset:512
  ds_read_b64_tr_b16 v[112:113], v140 offset:0
  ds_read_b64_tr_b16 v[114:115], v140 offset:128
  ds_read_b64_tr_b16 v[116:117], v140 offset:256
  ds_read_b64_tr_b16 v[118:119], v140 offset:384
  ds_read_b64_tr_b16 v[172:173], v140 offset:512
  ds_read_b64_tr_b16 v[174:175], v140 offset:640
  ds_read_b64_tr_b16 v[176:177], v140 offset:768
  ds_read_b64_tr_b16 v[178:179], v140 offset:896
  ds_read_b128 v[156:159], v138 offset:1024
  ds_read_b64 v[160:161], v139 offset:1024
  s_waitcnt vmcnt(14) lgkmcnt(13)
  v_mfma_f32_32x32x16_bf16 v[64:79], v[144:147], v[124:127], v[48:63]
  buffer_load_dwordx4 a[128:131], v171, s[20:23], s4 offen offset:2048 sc1
  buffer_load_dwordx4 a[132:135], v171, s[20:23], s4 offen offset:3072 sc1
  s_waitcnt vmcnt(15) lgkmcnt(12)
  v_mfma_f32_32x32x8_bf16 v[64:79], v[148:149], v[128:129], v[64:79]
  s_nop 11
  v_exp_f32 v64, v64
  s_waitcnt lgkmcnt(11)
  v_mfma_f32_32x32x16_bf16 v[80:95], v[150:153], v[124:127], 0
  v_exp_f32 v65, v65
  v_exp_f32 v66, v66
  v_exp_f32_e64 v67, v67
  v_cvt_pk_bf16_f32 v64, v64, v65
  v_exp_f32 v68, v68
  s_waitcnt lgkmcnt(10)
  v_mfma_f32_32x32x8_bf16 v[80:95], v[154:155], v[128:129], v[80:95]
  v_exp_f32_e64 v69, v69
  v_cvt_pk_bf16_f32 v65, v66, v67
  ds_read_b128 v[144:147], v138 offset:1536
  v_exp_f32 v70, v70
  v_exp_f32 v71, v71
  ds_read_b64 v[148:149], v139 offset:1536
  v_cvt_pk_bf16_f32 v66, v68, v69
  v_exp_f32 v72, v72
  v_exp_f32 v73, v73
  v_cvt_pk_bf16_f32 v67, v70, v71
  v_exp_f32 v74, v74
  v_exp_f32 v75, v75
  v_cvt_pk_bf16_f32 v68, v72, v73
  v_exp_f32_e64 v76, v76
  s_add_u32 s4, s94, 1970176
  buffer_load_dwordx4 a[136:139], v171, s[20:23], s4 offen offset:0 sc1
  v_exp_f32_e64 v77, v77
  v_cvt_pk_bf16_f32 v69, v74, v75
  v_exp_f32 v78, v78
  v_exp_f32 v79, v79
  v_cvt_pk_bf16_f32 v70, v76, v77
  v_cvt_pk_bf16_f32 v71, v78, v79
  v_exp_f32 v80, v80
  s_waitcnt vmcnt(14)
  v_mfma_f32_32x32x16_bf16 v[96:111], v[150:153], v[134:137], v[48:63]
  v_exp_f32 v81, v81
  v_exp_f32 v82, v82
  ds_read_b64_tr_b16 v[162:163], v140 offset:1024
  v_exp_f32_e64 v83, v83
  s_add_u32 s4, s94, 81920
  buffer_load_dwordx4 a[140:143], v171, s[20:23], s4 offen offset:0 sc1
  v_cvt_pk_bf16_f32 v80, v80, v81
  v_exp_f32 v84, v84
  s_waitcnt vmcnt(14)
  v_mfma_f32_32x32x8_bf16 v[96:111], v[154:155], v[130:131], v[96:111]
  v_exp_f32_e64 v85, v85
  ds_read_b64_tr_b16 v[164:165], v140 offset:1152
  v_cvt_pk_bf16_f32 v81, v82, v83
  v_exp_f32 v86, v86
  v_exp_f32 v87, v87
  v_cvt_pk_bf16_f32 v82, v84, v85
  ds_read_b64_tr_b16 v[166:167], v140 offset:1280
  v_exp_f32 v88, v88
  s_waitcnt lgkmcnt(3)
  v_mfma_f32_32x32x16_bf16 v[0:15], v[112:115], v[64:67], 0
  buffer_load_dwordx4 a[144:147], v171, s[20:23], s4 offen offset:1024 sc1
  v_exp_f32_e64 v89, v89
  v_cvt_pk_bf16_f32 v83, v86, v87
  v_exp_f32_e64 v90, v90
  ds_read_b64_tr_b16 v[168:169], v140 offset:1408
  v_exp_f32_e64 v91, v91
  v_cvt_pk_bf16_f32 v84, v88, v89
  v_mfma_f32_32x32x16_bf16 v[0:15], v[116:119], v[68:71], v[0:15]
  v_exp_f32 v92, v92
  v_exp_f32 v93, v93
  v_cvt_pk_bf16_f32 v85, v90, v91
  v_exp_f32 v94, v94
  v_exp_f32 v95, v95
  v_cvt_pk_bf16_f32 v86, v92, v93
  buffer_load_dwordx4 a[148:151], v171, s[20:23], s4 offen offset:2048 sc1
  v_cvt_pk_bf16_f32 v87, v94, v95
  v_exp_f32_e64 v96, v96
  v_mfma_f32_32x32x16_bf16 v[64:79], v[156:159], v[124:127], 0
  v_exp_f32 v97, v97
  v_exp_f32 v98, v98
  v_exp_f32_e64 v99, v99
  v_cvt_pk_bf16_f32 v96, v96, v97
  v_exp_f32_e64 v100, v100
  v_mfma_f32_32x32x8_bf16 v[64:79], v[160:161], v[128:129], v[64:79]
  v_exp_f32_e64 v101, v101
  v_cvt_pk_bf16_f32 v97, v98, v99
  ds_read_b128 v[150:153], v138 offset:2048
  v_exp_f32_e64 v102, v102
  buffer_load_dwordx4 a[152:155], v171, s[20:23], s4 offen offset:3072 sc1
  v_exp_f32_e64 v103, v103
  ds_read_b64 v[154:155], v139 offset:2048
  v_cvt_pk_bf16_f32 v98, v100, v101
  v_exp_f32_e64 v104, v104
  v_mfma_f32_32x32x16_bf16 v[0:15], v[172:175], v[80:83], v[0:15]
  v_exp_f32_e64 v105, v105
  v_cvt_pk_bf16_f32 v99, v102, v103
  v_exp_f32 v106, v106
  v_exp_f32 v107, v107
  v_cvt_pk_bf16_f32 v100, v104, v105
  v_mfma_f32_32x32x16_bf16 v[0:15], v[176:179], v[84:87], v[0:15]
  v_exp_f32_e64 v108, v108
  s_add_u32 s4, s94, 86016
  buffer_load_dwordx4 a[156:159], v171, s[20:23], s4 offen offset:0 sc1
  v_exp_f32_e64 v109, v109
  v_cvt_pk_bf16_f32 v101, v106, v107
  v_exp_f32 v110, v110
  v_exp_f32 v111, v111
  v_cvt_pk_bf16_f32 v102, v108, v109
  v_cvt_pk_bf16_f32 v103, v110, v111
  v_exp_f32_e64 v64, v64
  v_mfma_f32_32x32x16_bf16 v[80:95], v[156:159], v[134:137], 0
  v_exp_f32 v65, v65
  v_exp_f32 v66, v66
  ds_read_b64_tr_b16 v[112:113], v140 offset:1536
  v_exp_f32_e64 v67, v67
  v_cvt_pk_bf16_f32 v64, v64, v65
  s_add_u32 s4, s94, 409600
  buffer_load_dwordx4 a[160:163], v171, s[20:23], s4 offen offset:0 sc1
  v_exp_f32_e64 v68, v68
  v_mfma_f32_32x32x8_bf16 v[80:95], v[160:161], v[130:131], v[80:95]
  v_exp_f32 v69, v69
  ds_read_b64_tr_b16 v[114:115], v140 offset:1664
  v_cvt_pk_bf16_f32 v65, v66, v67
  s_waitcnt vmcnt(16)
  s_add_u32 s100, s41, 524288
  v_mov_b32 v189, s77
  s_mov_b64 exec, 1
  buffer_store_dword v189, off, s[20:23], s100 sc1
  s_mov_b64 exec, -1
  v_exp_f32 v70, v70
  v_exp_f32_e64 v71, v71
  v_cvt_pk_bf16_f32 v66, v68, v69
  ds_read_b64_tr_b16 v[116:117], v140 offset:1792
  v_exp_f32_e64 v72, v72
  v_mfma_f32_32x32x16_bf16 v[16:31], v[172:175], v[96:99], 0
  buffer_load_dwordx4 a[164:167], v171, s[20:23], s4 offen offset:1024 sc1
  v_exp_f32_e64 v73, v73
  v_cvt_pk_bf16_f32 v67, v70, v71
  v_exp_f32_e64 v74, v74
  ds_read_b64_tr_b16 v[118:119], v140 offset:1920
  v_exp_f32_e64 v75, v75
  v_cvt_pk_bf16_f32 v68, v72, v73
  v_mfma_f32_32x32x16_bf16 v[16:31], v[176:179], v[100:103], v[16:31]
  v_exp_f32 v76, v76
  v_exp_f32 v77, v77
  v_cvt_pk_bf16_f32 v69, v74, v75
  v_exp_f32 v78, v78
  v_exp_f32 v79, v79
  buffer_load_dwordx4 a[168:171], v171, s[20:23], s4 offen offset:2048 sc1
  v_cvt_pk_bf16_f32 v70, v76, v77
  v_cvt_pk_bf16_f32 v71, v78, v79
  v_exp_f32_e64 v80, v80
  v_mfma_f32_32x32x16_bf16 v[96:111], v[144:147], v[124:127], 0
  v_exp_f32 v81, v81
  v_exp_f32 v82, v82
  v_exp_f32_e64 v83, v83
  v_cvt_pk_bf16_f32 v80, v80, v81
  v_exp_f32_e64 v84, v84
  v_mfma_f32_32x32x8_bf16 v[96:111], v[148:149], v[128:129], v[96:111]
  v_exp_f32_e64 v85, v85
  buffer_load_dwordx4 a[172:175], v171, s[20:23], s4 offen offset:3072 sc1
  v_cvt_pk_bf16_f32 v81, v82, v83
  ds_read_b128 v[156:159], v138 offset:2560
  s_lshl_b32 s72, s86, 12
  s_add_u32 s72, s72, 131072
  v_and_b32 v188, 31, v190
  v_lshl_add_u32 v188, v188, 7, s72
  buffer_load_dword v189, v188, s[20:23], 0 offen sc1
  v_lshrrev_b32 v180, 4, v190
  v_and_b32 v181, 15, v190
  v_lshlrev_b32_e64 v180, 9, v180
  v_lshl_add_u32 v141, v181, 4, v180
  v_add_u32 v142, 110592, v141
  v_add_u32 v143, 32768, v141
  v_lshl_add_u32 v120, v181, 3, v180
  v_add_u32 v121, 8192, v120
  s_mul_i32 s95, s86, 216
  s_lshl_b32 s72, s53, 1
  s_add_u32 s95, s95, s72
  s_lshl_b32 s95, s95, 10
  s_add_u32 s95, s95, 12582912
  s_mov_b32 s32, s56
  s_mov_b32 s33, s57
  s_mov_b32 s35, 0x20000
  s_cmp_lt_u32 s3, 2
  s_cselect_b32 s34, 24117248, 0
  v_exp_f32 v86, v86
  v_exp_f32 v87, v87
  ds_read_b64 v[160:161], v139 offset:2560
  v_cvt_pk_bf16_f32 v82, v84, v85
  v_exp_f32 v88, v88
  s_waitcnt lgkmcnt(2)
  v_mfma_f32_32x32x16_bf16 v[0:15], v[162:165], v[64:67], v[0:15]
  v_exp_f32_e64 v89, v89
  v_cvt_pk_bf16_f32 v83, v86, v87
  v_exp_f32 v90, v90
  v_exp_f32 v91, v91
  v_cvt_pk_bf16_f32 v84, v88, v89
  v_mfma_f32_32x32x16_bf16 v[0:15], v[166:169], v[68:71], v[0:15]
  s_add_u32 s4, s94, 413696
  buffer_load_dwordx4 a[176:179], v171, s[20:23], s4 offen offset:0 sc1
  v_exp_f32 v92, v92
  v_exp_f32 v93, v93
  v_cvt_pk_bf16_f32 v85, v90, v91
  v_exp_f32 v94, v94
  v_exp_f32 v95, v95
  v_cvt_pk_bf16_f32 v86, v92, v93
  v_cvt_pk_bf16_f32 v87, v94, v95
  v_exp_f32_e64 v96, v96
  v_mfma_f32_32x32x16_bf16 v[64:79], v[144:147], v[134:137], 0
  v_exp_f32 v97, v97
  v_exp_f32 v98, v98
  s_add_u32 s4, s94, 737280
  buffer_load_dwordx4 a[180:183], v171, s[20:23], s4 offen offset:0 sc1
  ds_read_b64_tr_b16 v[172:173], v140 offset:2048
  v_exp_f32_e64 v99, v99
  v_cvt_pk_bf16_f32 v96, v96, v97
  v_exp_f32_e64 v100, v100
  v_mfma_f32_32x32x8_bf16 v[64:79], v[148:149], v[130:131], v[64:79]
  v_exp_f32_e64 v101, v101
  ds_read_b64_tr_b16 v[174:175], v140 offset:2176
  v_cvt_pk_bf16_f32 v97, v98, v99
  v_exp_f32 v102, v102
  v_exp_f32 v103, v103
  v_cvt_pk_bf16_f32 v98, v100, v101
  ds_read_b64_tr_b16 v[176:177], v140 offset:2304
  v_exp_f32_e64 v104, v104
  v_mfma_f32_32x32x16_bf16 v[16:31], v[162:165], v[80:83], v[16:31]
  buffer_load_dwordx4 a[184:187], v171, s[20:23], s4 offen offset:1024 sc1
  v_exp_f32_e64 v105, v105
  v_cvt_pk_bf16_f32 v99, v102, v103
  v_exp_f32_e64 v106, v106
  ds_read_b64_tr_b16 v[178:179], v140 offset:2432
  v_exp_f32_e64 v107, v107
  v_cvt_pk_bf16_f32 v100, v104, v105
  v_mfma_f32_32x32x16_bf16 v[16:31], v[166:169], v[84:87], v[16:31]
  v_exp_f32 v108, v108
  v_exp_f32 v109, v109
  v_cvt_pk_bf16_f32 v101, v106, v107
  v_exp_f32 v110, v110
  v_exp_f32 v111, v111
  v_cvt_pk_bf16_f32 v102, v108, v109
  buffer_load_dwordx4 a[188:191], v171, s[20:23], s4 offen offset:2048 sc1
  v_cvt_pk_bf16_f32 v103, v110, v111
  v_exp_f32_e64 v64, v64
  v_mfma_f32_32x32x16_bf16 v[80:95], v[150:153], v[124:127], 0
  v_exp_f32 v65, v65
  v_exp_f32 v66, v66
  v_exp_f32_e64 v67, v67
  v_cvt_pk_bf16_f32 v64, v64, v65
  v_exp_f32_e64 v68, v68
  v_mfma_f32_32x32x8_bf16 v[80:95], v[154:155], v[128:129], v[80:95]
  v_exp_f32_e64 v69, v69
  v_cvt_pk_bf16_f32 v65, v66, v67
  ds_read_b128 v[144:147], v138 offset:3072
  v_exp_f32_e64 v70, v70
  buffer_load_dwordx4 a[192:195], v171, s[20:23], s4 offen offset:3072 sc1
  v_exp_f32_e64 v71, v71
  ds_read_b64 v[148:149], v139 offset:3072
  v_cvt_pk_bf16_f32 v66, v68, v69
  v_exp_f32_e64 v72, v72
  v_mfma_f32_32x32x16_bf16 v[0:15], v[112:115], v[96:99], v[0:15]
  v_exp_f32_e64 v73, v73
  v_cvt_pk_bf16_f32 v67, v70, v71
  v_exp_f32 v74, v74
  v_exp_f32 v75, v75
  v_cvt_pk_bf16_f32 v68, v72, v73
  v_mfma_f32_32x32x16_bf16 v[0:15], v[116:119], v[100:103], v[0:15]
  s_add_u32 s4, s94, 741376
  buffer_load_dwordx4 a[196:199], v171, s[20:23], s4 offen offset:0 sc1
  v_exp_f32 v76, v76
  v_exp_f32 v77, v77
  v_cvt_pk_bf16_f32 v69, v74, v75
  v_exp_f32 v78, v78
  v_exp_f32 v79, v79
  v_cvt_pk_bf16_f32 v70, v76, v77
  v_cvt_pk_bf16_f32 v71, v78, v79
  v_exp_f32_e64 v80, v80
  v_mfma_f32_32x32x16_bf16 v[96:111], v[150:153], v[134:137], 0
  v_exp_f32 v81, v81
  v_exp_f32 v82, v82
  ds_read_b64_tr_b16 v[162:163], v140 offset:2560
  v_exp_f32_e64 v83, v83
  s_add_u32 s4, s94, 1064960
  buffer_load_dwordx4 a[200:203], v171, s[20:23], s4 offen offset:0 sc1
  v_cvt_pk_bf16_f32 v80, v80, v81
  v_exp_f32_e64 v84, v84
  v_mfma_f32_32x32x8_bf16 v[96:111], v[154:155], v[130:131], v[96:111]
  v_exp_f32_e64 v85, v85
  ds_read_b64_tr_b16 v[164:165], v140 offset:2688
  v_cvt_pk_bf16_f32 v81, v82, v83
  v_exp_f32 v86, v86
  v_exp_f32 v87, v87
  v_cvt_pk_bf16_f32 v82, v84, v85
  ds_read_b64_tr_b16 v[166:167], v140 offset:2816
  v_exp_f32_e64 v88, v88
  v_mfma_f32_32x32x16_bf16 v[16:31], v[112:115], v[64:67], v[16:31]
  v_exp_f32_e64 v89, v89
  buffer_load_dwordx4 a[204:207], v171, s[20:23], s4 offen offset:1024 sc1
  v_cvt_pk_bf16_f32 v83, v86, v87
  v_exp_f32_e64 v90, v90
  ds_read_b64_tr_b16 v[168:169], v140 offset:2944
  v_exp_f32_e64 v91, v91
  v_cvt_pk_bf16_f32 v84, v88, v89
  v_mfma_f32_32x32x16_bf16 v[16:31], v[116:119], v[68:71], v[16:31]
  v_exp_f32 v92, v92
  v_exp_f32 v93, v93
  v_cvt_pk_bf16_f32 v85, v90, v91
  v_exp_f32 v94, v94
  v_exp_f32 v95, v95
  v_cvt_pk_bf16_f32 v86, v92, v93
  v_cvt_pk_bf16_f32 v87, v94, v95
  v_exp_f32 v96, v96
  buffer_load_dwordx4 a[208:211], v171, s[20:23], s4 offen offset:2048 sc1
  s_waitcnt lgkmcnt(3)
  v_mfma_f32_32x32x16_bf16 v[64:79], v[156:159], v[124:127], 0
  v_exp_f32 v97, v97
  v_exp_f32 v98, v98
  v_exp_f32_e64 v99, v99
  v_cvt_pk_bf16_f32 v96, v96, v97
  v_exp_f32_e64 v100, v100
  v_mfma_f32_32x32x8_bf16 v[64:79], v[160:161], v[128:129], v[64:79]
  v_exp_f32_e64 v101, v101
  v_cvt_pk_bf16_f32 v97, v98, v99
  ds_read_b128 v[150:153], v138 offset:3584
  v_exp_f32_e64 v102, v102
  buffer_load_dwordx4 a[212:215], v171, s[20:23], s4 offen offset:3072 sc1
  v_exp_f32_e64 v103, v103
  ds_read_b64 v[154:155], v139 offset:3584
  v_cvt_pk_bf16_f32 v98, v100, v101
  v_exp_f32_e64 v104, v104
  v_mfma_f32_32x32x16_bf16 v[0:15], v[172:175], v[80:83], v[0:15]
  v_exp_f32_e64 v105, v105
  v_cvt_pk_bf16_f32 v99, v102, v103
  v_exp_f32 v106, v106
  v_exp_f32 v107, v107
  v_cvt_pk_bf16_f32 v100, v104, v105
  v_mfma_f32_32x32x16_bf16 v[0:15], v[176:179], v[84:87], v[0:15]
  v_exp_f32_e64 v108, v108
  s_add_u32 s4, s94, 1069056
  buffer_load_dwordx4 a[216:219], v171, s[20:23], s4 offen offset:0 sc1
  v_exp_f32_e64 v109, v109
  v_cvt_pk_bf16_f32 v101, v106, v107
  v_exp_f32 v110, v110
  v_exp_f32 v111, v111
  v_cvt_pk_bf16_f32 v102, v108, v109
  v_cvt_pk_bf16_f32 v103, v110, v111
  v_exp_f32_e64 v64, v64
  v_mfma_f32_32x32x16_bf16 v[80:95], v[156:159], v[134:137], 0
  v_exp_f32 v65, v65
  v_exp_f32 v66, v66
  ds_read_b64_tr_b16 v[112:113], v140 offset:3072
  v_exp_f32_e64 v67, v67
  v_cvt_pk_bf16_f32 v64, v64, v65
  s_add_u32 s4, s94, 1392640
  buffer_load_dwordx4 a[220:223], v171, s[20:23], s4 offen offset:0 sc1
  v_exp_f32_e64 v68, v68
  v_mfma_f32_32x32x8_bf16 v[80:95], v[160:161], v[130:131], v[80:95]
  v_exp_f32_e64 v69, v69
  ds_read_b64_tr_b16 v[114:115], v140 offset:3200
  v_cvt_pk_bf16_f32 v65, v66, v67
  s_waitcnt vmcnt(12)
  v_cmp_ne_u32 vcc, s77, v189
  s_mov_b32 s97, 0
  s_cbranch_vccz Lpoll_749012_ok
Lpoll_749012:
  s_sleep 1
  buffer_load_dword v189, v188, s[20:23], 0 offen sc1
  s_add_u32 s97, s97, 1
  s_waitcnt vmcnt(0)
  v_cmp_ne_u32 vcc, s77, v189
  s_cmp_gt_u32 s97, 32768
  s_cbranch_scc1 Lpoll_749012_ok
  s_cbranch_vccnz Lpoll_749012
Lpoll_749012_ok:
  s_mov_b32 s28, s50
  s_mov_b32 s29, s51
  s_mov_b32 s31, 0x20000
  s_cmp_eq_u32 s3, 0
  s_cselect_b32 s30, 1280, 0
  s_mul_i32 s96, s87, 160
  v_lshrrev_b32 v182, 4, v190
  v_lshlrev_b32 v182, 3, v182
  v_add_u32 v182, s96, v182
  buffer_load_dwordx4 a[224:227], v171, s[20:23], s4 offen offset:1024 sc1
  buffer_load_dwordx2 v[244:245], v182, s[28:31], 0 offen offset:0
  buffer_load_dwordx2 v[246:247], v182, s[28:31], 0 offen offset:32
  buffer_load_dwordx2 v[248:249], v182, s[28:31], 0 offen offset:64
  buffer_load_dwordx2 v[250:251], v182, s[28:31], 0 offen offset:96
  buffer_load_dwordx2 v[252:253], v182, s[28:31], 0 offen offset:128
  v_exp_f32 v70, v70
  v_exp_f32 v71, v71
  v_cvt_pk_bf16_f32 v66, v68, v69
  ds_read_b64_tr_b16 v[116:117], v140 offset:3328
  v_exp_f32_e64 v72, v72
  v_mfma_f32_32x32x16_bf16 v[16:31], v[172:175], v[96:99], v[16:31]
  v_exp_f32_e64 v73, v73
  v_cvt_pk_bf16_f32 v67, v70, v71
  v_exp_f32_e64 v74, v74
  ds_read_b64_tr_b16 v[118:119], v140 offset:3456
  v_exp_f32_e64 v75, v75
  v_cvt_pk_bf16_f32 v68, v72, v73
  v_mfma_f32_32x32x16_bf16 v[16:31], v[176:179], v[100:103], v[16:31]
  v_exp_f32 v76, v76
  v_exp_f32 v77, v77
  v_cvt_pk_bf16_f32 v69, v74, v75
  v_exp_f32 v78, v78
  v_exp_f32 v79, v79
  v_cvt_pk_bf16_f32 v70, v76, v77
  v_cvt_pk_bf16_f32 v71, v78, v79
  v_exp_f32_e64 v80, v80
  v_mfma_f32_32x32x16_bf16 v[96:111], v[144:147], v[124:127], 0
  v_exp_f32 v81, v81
  v_exp_f32 v82, v82
  v_exp_f32_e64 v83, v83
  v_cvt_pk_bf16_f32 v80, v80, v81
  v_exp_f32_e64 v84, v84
  buffer_load_dwordx4 a[228:231], v171, s[20:23], s4 offen offset:2048 sc1
  v_mfma_f32_32x32x8_bf16 v[96:111], v[148:149], v[128:129], v[96:111]
  v_exp_f32_e64 v85, v85
  v_cvt_pk_bf16_f32 v81, v82, v83
  ds_read_b128 v[156:159], v138 offset:4096
  v_exp_f32 v86, v86
  v_exp_f32 v87, v87
  ds_read_b64 v[160:161], v139 offset:4096
  v_cvt_pk_bf16_f32 v82, v84, v85
  v_exp_f32 v88, v88
  s_waitcnt lgkmcnt(3)
  v_mfma_f32_32x32x16_bf16 v[0:15], v[162:165], v[64:67], v[0:15]
  v_exp_f32_e64 v89, v89
  v_cvt_pk_bf16_f32 v83, v86, v87
  buffer_load_dwordx4 a[232:235], v171, s[20:23], s4 offen offset:3072 sc1
  v_exp_f32 v90, v90
  v_exp_f32 v91, v91
  v_cvt_pk_bf16_f32 v84, v88, v89
  v_mfma_f32_32x32x16_bf16 v[0:15], v[166:169], v[68:71], v[0:15]
  v_exp_f32 v92, v92
  v_exp_f32 v93, v93
  v_cvt_pk_bf16_f32 v85, v90, v91
  v_exp_f32 v94, v94
  v_exp_f32 v95, v95
  v_cvt_pk_bf16_f32 v86, v92, v93
  v_cvt_pk_bf16_f32 v87, v94, v95
  v_exp_f32_e64 v96, v96
  v_mfma_f32_32x32x16_bf16 v[64:79], v[144:147], v[134:137], 0
  s_add_u32 s4, s94, 1396736
  buffer_load_dwordx4 a[236:239], v171, s[20:23], s4 offen offset:0 sc1
  v_exp_f32 v97, v97
  v_exp_f32 v98, v98
  ds_read_b64_tr_b16 v[172:173], v140 offset:3584
  v_exp_f32_e64 v99, v99
  v_cvt_pk_bf16_f32 v96, v96, v97
  v_exp_f32_e64 v100, v100
  v_mfma_f32_32x32x8_bf16 v[64:79], v[148:149], v[130:131], v[64:79]
  v_exp_f32_e64 v101, v101
  ds_read_b64_tr_b16 v[174:175], v140 offset:3712
  v_cvt_pk_bf16_f32 v97, v98, v99
  v_exp_f32 v102, v102
  v_exp_f32 v103, v103
  s_add_u32 s4, s94, 1720320
  buffer_load_dwordx4 a[240:243], v171, s[20:23], s4 offen offset:0 sc1
  v_cvt_pk_bf16_f32 v98, v100, v101
  ds_read_b64_tr_b16 v[176:177], v140 offset:3840
  v_exp_f32_e64 v104, v104
  v_mfma_f32_32x32x16_bf16 v[16:31], v[162:165], v[80:83], v[16:31]
  v_exp_f32_e64 v105, v105
  v_cvt_pk_bf16_f32 v99, v102, v103
  v_exp_f32_e64 v106, v106
  ds_read_b64_tr_b16 v[178:179], v140 offset:3968
  v_exp_f32_e64 v107, v107
  v_cvt_pk_bf16_f32 v100, v104, v105
  v_mfma_f32_32x32x16_bf16 v[16:31], v[166:169], v[84:87], v[16:31]
  v_exp_f32 v108, v108
  v_exp_f32 v109, v109
  buffer_load_dwordx4 a[244:247], v171, s[20:23], s4 offen offset:1024 sc1
  v_cvt_pk_bf16_f32 v101, v106, v107
  v_exp_f32 v110, v110
  v_exp_f32 v111, v111
  v_cvt_pk_bf16_f32 v102, v108, v109
  v_cvt_pk_bf16_f32 v103, v110, v111
  v_exp_f32_e64 v64, v64
  v_mfma_f32_32x32x16_bf16 v[80:95], v[150:153], v[124:127], 0
  v_exp_f32 v65, v65
  v_exp_f32 v66, v66
  v_exp_f32_e64 v67, v67
  v_cvt_pk_bf16_f32 v64, v64, v65
  v_exp_f32_e64 v68, v68
  v_mfma_f32_32x32x8_bf16 v[80:95], v[154:155], v[128:129], v[80:95]
  buffer_load_dwordx4 a[248:251], v171, s[20:23], s4 offen offset:2048 sc1
  v_exp_f32_e64 v69, v69
  v_cvt_pk_bf16_f32 v65, v66, v67
  ds_read_b128 v[144:147], v138 offset:4608
  v_exp_f32 v70, v70
  v_exp_f32 v71, v71
  ds_read_b64 v[148:149], v139 offset:4608
  v_cvt_pk_bf16_f32 v66, v68, v69
  v_exp_f32_e64 v72, v72
  v_mfma_f32_32x32x16_bf16 v[0:15], v[112:115], v[96:99], v[0:15]
  v_exp_f32_e64 v73, v73
  v_cvt_pk_bf16_f32 v67, v70, v71
  v_exp_f32_e64 v74, v74
  buffer_load_dwordx4 a[252:255], v171, s[20:23], s4 offen offset:3072 sc1
  v_exp_f32 v75, v75
  v_cvt_pk_bf16_f32 v68, v72, v73
  s_waitcnt lgkmcnt(2)
  v_mfma_f32_32x32x16_bf16 v[0:15], v[116:119], v[100:103], v[0:15]
  v_exp_f32 v76, v76
  v_exp_f32 v77, v77
  v_cvt_pk_bf16_f32 v69, v74, v75
  v_exp_f32 v78, v78
  v_exp_f32 v79, v79
  v_cvt_pk_bf16_f32 v70, v76, v77
  v_cvt_pk_bf16_f32 v71, v78, v79
  v_exp_f32_e64 v80, v80
  v_mfma_f32_32x32x16_bf16 v[96:111], v[150:153], v[134:137], 0
  v_exp_f32_e64 v81, v81
  s_add_u32 s4, s94, 1724416
  buffer_load_dwordx4 v[240:243], v171, s[20:23], s4 offen offset:0 sc1
  v_exp_f32_e64 v82, v82
  ds_read_b64_tr_b16 v[162:163], v140 offset:4096
  v_exp_f32_e64 v83, v83
  v_cvt_pk_bf16_f32 v80, v80, v81
  v_exp_f32_e64 v84, v84
  v_mfma_f32_32x32x8_bf16 v[96:111], v[154:155], v[130:131], v[96:111]
  v_exp_f32_e64 v85, v85
  ds_read_b64_tr_b16 v[164:165], v140 offset:4224
  v_cvt_pk_bf16_f32 v81, v82, v83
  v_exp_f32 v86, v86
  v_exp_f32 v87, v87
  v_cvt_pk_bf16_f32 v82, v84, v85
  ds_read_b64_tr_b16 v[166:167], v140 offset:4352
  v_exp_f32_e64 v88, v88
  s_add_u32 m0, s92, 90112
  s_add_u32 s4, s52, 2540544
  buffer_load_dwordx4 v171, s[20:23], s4 offen sc1 lds
  v_mfma_f32_32x32x16_bf16 v[16:31], v[112:115], v[64:67], v[16:31]
  v_exp_f32_e64 v89, v89
  v_cvt_pk_bf16_f32 v83, v86, v87
  v_exp_f32_e64 v90, v90
  ds_read_b64_tr_b16 v[168:169], v140 offset:4480
  v_exp_f32_e64 v91, v91
  v_cvt_pk_bf16_f32 v84, v88, v89
  v_mfma_f32_32x32x16_bf16 v[16:31], v[116:119], v[68:71], v[16:31]
  v_exp_f32 v92, v92
  v_exp_f32 v93, v93
  v_cvt_pk_bf16_f32 v85, v90, v91
  s_add_u32 m0, s92, 91136
  s_add_u32 s4, s52, 2541568
  buffer_load_dwordx4 v171, s[20:23], s4 offen sc1 lds
  v_exp_f32 v94, v94
  v_exp_f32 v95, v95
  v_cvt_pk_bf16_f32 v86, v92, v93
  v_cvt_pk_bf16_f32 v87, v94, v95
  v_exp_f32_e64 v96, v96
  v_mfma_f32_32x32x16_bf16 v[64:79], v[156:159], v[124:127], v[32:47]
  v_exp_f32 v97, v97
  v_exp_f32 v98, v98
  v_exp_f32_e64 v99, v99
  v_cvt_pk_bf16_f32 v96, v96, v97
  v_exp_f32_e64 v100, v100
  s_add_u32 m0, s92, 131072
  s_add_u32 s4, s52, 2542592
  buffer_load_dwordx4 v171, s[20:23], s4 offen sc1 lds
  v_mfma_f32_32x32x8_bf16 v[64:79], v[160:161], v[128:129], v[64:79]
  v_exp_f32 v101, v101
  v_cvt_pk_bf16_f32 v97, v98, v99
  s_lshl_b32 s72, s86, 12
  s_add_u32 s72, s72, 524288
  v_and_b32_e64 v188, 31, v190
  v_lshl_add_u32 v188, v188, 7, s72
  buffer_load_dword v189, v188, s[20:23], 0 offen sc1
  v_exp_f32 v102, v102
  v_exp_f32 v103, v103
  v_cvt_pk_bf16_f32 v98, v100, v101
  v_exp_f32_e64 v104, v104
  v_mfma_f32_32x32x16_bf16 v[0:15], v[172:175], v[80:83], v[0:15]
  v_exp_f32_e64 v105, v105
  v_cvt_pk_bf16_f32 v99, v102, v103
  v_exp_f32 v106, v106
  v_exp_f32 v107, v107
  v_cvt_pk_bf16_f32 v100, v104, v105
  v_mfma_f32_32x32x16_bf16 v[0:15], v[176:179], v[84:87], v[0:15]
  v_exp_f32 v108, v108
  v_exp_f32 v109, v109
  v_cvt_pk_bf16_f32 v101, v106, v107
  v_exp_f32 v110, v110
  v_exp_f32 v111, v111
  v_cvt_pk_bf16_f32 v102, v108, v109
  v_cvt_pk_bf16_f32 v103, v110, v111
  s_add_u32 m0, s92, 132096
  s_add_u32 s4, s52, 2543616
  buffer_load_dwordx4 v171, s[20:23], s4 offen sc1 lds
  v_exp_f32_e64 v64, v64
  v_mfma_f32_32x32x16_bf16 v[80:95], v[156:159], v[134:137], 0
  v_exp_f32 v65, v65
  v_exp_f32 v66, v66
  ds_read_b64_tr_b16 v[112:113], v140 offset:4608
  v_exp_f32_e64 v67, v67
  v_cvt_pk_bf16_f32 v64, v64, v65
  v_exp_f32_e64 v68, v68
  v_mfma_f32_32x32x8_bf16 v[80:95], v[160:161], v[130:131], v[80:95]
  v_exp_f32_e64 v69, v69
  ds_read_b64_tr_b16 v[114:115], v140 offset:4736
  v_cvt_pk_bf16_f32 v65, v66, v67
  s_add_u32 m0, s92, 139264
  s_add_u32 s4, s52, 2703360
  buffer_load_dwordx4 v171, s[20:23], s4 offen sc1 lds
  v_exp_f32 v70, v70
  v_exp_f32 v71, v71
  v_cvt_pk_bf16_f32 v66, v68, v69
  ds_read_b64_tr_b16 v[116:117], v140 offset:4864
  v_exp_f32_e64 v72, v72
  v_mfma_f32_32x32x16_bf16 v[16:31], v[172:175], v[96:99], v[16:31]
  v_exp_f32_e64 v73, v73
  v_cvt_pk_bf16_f32 v67, v70, v71
  v_exp_f32_e64 v74, v74
  ds_read_b64_tr_b16 v[118:119], v140 offset:4992
  v_exp_f32_e64 v75, v75
  v_cvt_pk_bf16_f32 v68, v72, v73
  v_mfma_f32_32x32x16_bf16 v[16:31], v[176:179], v[100:103], v[16:31]
  s_add_u32 m0, s92, 140288
  s_add_u32 s4, s52, 2704384
  buffer_load_dwordx4 v171, s[20:23], s4 offen sc1 lds
  v_exp_f32 v76, v76
  v_exp_f32 v77, v77
  v_cvt_pk_bf16_f32 v69, v74, v75
  v_exp_f32 v78, v78
  v_exp_f32 v79, v79
  v_cvt_pk_bf16_f32 v70, v76, v77
  v_cvt_pk_bf16_f32 v71, v78, v79
  v_exp_f32 v80, v80
  s_waitcnt lgkmcnt(3)
  v_mfma_f32_32x32x16_bf16 v[96:111], v[144:147], v[134:137], v[32:47]
  v_exp_f32 v81, v81
  v_exp_f32 v82, v82
  buffer_load_dwordx4 v[192:195], v141, s[20:23], s95 offen offset:0 sc1
  v_exp_f32_e64 v83, v83
  v_cvt_pk_bf16_f32 v80, v80, v81
  v_exp_f32_e64 v84, v84
  v_mfma_f32_32x32x8_bf16 v[96:111], v[148:149], v[130:131], v[96:111]
  v_exp_f32_e64 v85, v85
  v_cvt_pk_bf16_f32 v81, v82, v83
  v_exp_f32 v86, v86
  v_exp_f32 v87, v87
  v_cvt_pk_bf16_f32 v82, v84, v85
  v_exp_f32_e64 v88, v88
  v_mfma_f32_32x32x16_bf16 v[0:15], v[162:165], v[64:67], v[0:15]
  buffer_load_dwordx4 v[196:199], v141, s[20:23], s95 offen offset:256 sc1
  v_exp_f32_e64 v89, v89
  v_cvt_pk_bf16_f32 v83, v86, v87
  v_exp_f32 v90, v90
  v_exp_f32 v91, v91
  v_cvt_pk_bf16_f32 v84, v88, v89
  v_mfma_f32_32x32x16_bf16 v[0:15], v[166:169], v[68:71], v[0:15]
  v_exp_f32 v92, v92
  v_exp_f32 v93, v93
  v_cvt_pk_bf16_f32 v85, v90, v91
  v_exp_f32 v94, v94
  v_exp_f32 v95, v95
  v_cvt_pk_bf16_f32 v86, v92, v93
  v_cvt_pk_bf16_f32 v87, v94, v95
  buffer_load_dwordx4 v[200:203], v142, s[20:23], s95 offen offset:0 sc1
  v_exp_f32 v96, v96
  v_exp_f32 v97, v97
  v_exp_f32 v98, v98
  v_exp_f32 v99, v99
  v_cvt_pk_bf16_f32 v96, v96, v97
  v_exp_f32 v100, v100
  v_exp_f32 v101, v101
  v_cvt_pk_bf16_f32 v97, v98, v99
  v_exp_f32 v102, v102
  v_exp_f32 v103, v103
  v_cvt_pk_bf16_f32 v98, v100, v101
  v_exp_f32_e64 v104, v104
  v_mfma_f32_32x32x16_bf16 v[16:31], v[162:165], v[80:83], v[16:31]
  buffer_load_dwordx4 v[204:207], v142, s[20:23], s95 offen offset:256 sc1
  v_exp_f32_e64 v105, v105
  v_cvt_pk_bf16_f32 v99, v102, v103
  v_exp_f32 v106, v106
  v_exp_f32 v107, v107
  v_cvt_pk_bf16_f32 v100, v104, v105
  v_mfma_f32_32x32x16_bf16 v[16:31], v[166:169], v[84:87], v[16:31]
  v_exp_f32 v108, v108
  v_exp_f32 v109, v109
  v_cvt_pk_bf16_f32 v101, v106, v107
  v_exp_f32 v110, v110
  v_exp_f32 v111, v111
  v_cvt_pk_bf16_f32 v102, v108, v109
  v_cvt_pk_bf16_f32 v103, v110, v111
  s_add_u32 s95, s95, 16384
  buffer_load_dwordx4 v[208:211], v141, s[20:23], s95 offen offset:0 sc1
  s_waitcnt lgkmcnt(0)
  v_mfma_f32_32x32x16_bf16 v[16:31], v[112:115], v[96:99], v[16:31]
  v_mfma_f32_32x32x16_bf16 v[16:31], v[116:119], v[100:103], v[16:31]
  v_subrev_u32 v180, 729808896, v8
  s_mov_b32 s65, 671088640
  s_nop 9
  v_subrev_u32 v181, 729808896, v24
  v_max_u32 v180, v180, v181
  v_cmp_lt_u32 vcc, s65, v180
  s_nop 0
  s_cmp_lg_u32 vcc_hi, 0
  s_cbranch_scc1 L_slow
L_back:
  s_lshl_b32 s65, s85, 2
  s_add_u32 s65, s65, s3
  s_lshl_b32 s99, s65, 5
  s_add_u32 s99, s99, s84
  s_lshl_b32 s99, s99, 7
  s_lshl_b32 s65, s65, 6
  s_add_u32 s65, s65, s84
  s_lshl_b32 s66, s65, 10
  s_add_u32 s66, s66, 19922944
  s_lshl_b32 s67, s65, 8
  s_add_u32 s67, s67, 22020096
  s_add_u32 s68, s66, 32768
  s_add_u32 s69, s67, 8192
  v_lshrrev_b32_e64 v67, 5, v190
  buffer_load_dwordx4 v[212:215], v141, s[20:23], s95 offen offset:256 sc1
  v_lshlrev_b32_e64 v67, 30, v67
  v_lshl_or_b32 v67, v190, 3, v67
  v_mov_b32 v64, v8
  v_mov_b32 v65, v8
  s_nop 1
  v_permlane32_swap_b32 v64, v65
  v_rcp_f32 v65, v65
  s_nop 0
  v_mul_f32 v0, v65, v0
  v_mul_f32 v1, v65, v1
  v_mul_f32_e64 v2, v65, v2
  buffer_load_dwordx4 v[216:219], v142, s[20:23], s95 offen offset:0 sc1
  v_mul_f32 v3, v65, v3
  v_mul_f32 v4, v65, v4
  v_mul_f32 v5, v65, v5
  v_mul_f32 v6, v65, v6
  v_mul_f32 v7, v65, v7
  v_mul_f32 v8, v65, v8
  v_mul_f32 v9, v65, v9
  v_mul_f32 v10, v65, v10
  v_mul_f32_e64 v11, v65, v11
  v_cvt_pk_bf16_f32 v0, v0, v1
  v_cvt_pk_bf16_f32 v1, v2, v3
  v_cvt_pk_bf16_f32 v2, v4, v5
  v_cvt_pk_bf16_f32 v3, v6, v7
  v_cvt_pk_bf16_f32 v4, v8, v9
  v_cvt_pk_bf16_f32 v5, v10, v11
  buffer_store_dwordx4 v[0:3], v171, s[20:23], s66 offen sc1
  buffer_store_dwordx2 v[4:5], v67, s[20:23], s67 offen sc1
  v_mov_b32 v64, v24
  v_mov_b32 v65, v24
  s_nop 1
  v_permlane32_swap_b32 v64, v65
  v_rcp_f32 v65, v65
  s_nop 0
  v_mul_f32 v16, v65, v16
  v_mul_f32 v17, v65, v17
  v_mul_f32 v18, v65, v18
  v_mul_f32 v19, v65, v19
  v_mul_f32_e64 v20, v65, v20
  buffer_load_dwordx4 v[220:223], v142, s[20:23], s95 offen offset:256 sc1
  v_mul_f32 v21, v65, v21
  v_mul_f32 v22, v65, v22
  v_mul_f32 v23, v65, v23
  v_mul_f32 v24, v65, v24
  v_mul_f32 v25, v65, v25
  v_mul_f32 v26, v65, v26
  v_mul_f32_e64 v27, v65, v27
  v_cvt_pk_bf16_f32 v16, v16, v17
  v_cvt_pk_bf16_f32 v17, v18, v19
  v_cvt_pk_bf16_f32 v18, v20, v21
  v_cvt_pk_bf16_f32 v19, v22, v23
  v_cvt_pk_bf16_f32 v20, v24, v25
  v_cvt_pk_bf16_f32 v21, v26, v27
  buffer_store_dwordx4 v[16:19], v171, s[20:23], s68 offen sc1
  buffer_store_dwordx2 v[20:21], v67, s[20:23], s69 offen sc1
  s_waitcnt vmcnt(31)
  v_lshlrev_b32 v80, 16, v244
  v_and_b32 v81, 0xffff0000, v244
  v_lshlrev_b32_e64 v82, 16, v245
  v_and_b32 v83, 0xffff0000, v245
  s_waitcnt vmcnt(30)
  v_lshlrev_b32 v84, 16, v246
  v_and_b32 v85, 0xffff0000, v246
  v_lshlrev_b32_e64 v86, 16, v247
  s_add_u32 s95, s95, 16384
  buffer_load_dwordx4 v[224:227], v141, s[20:23], s95 offen offset:0 sc1
  v_and_b32 v87, 0xffff0000, v247
  s_waitcnt vmcnt(30)
  v_lshlrev_b32 v88, 16, v248
  v_and_b32 v89, 0xffff0000, v248
  v_lshlrev_b32_e64 v90, 16, v249
  v_and_b32 v91, 0xffff0000, v249
  s_waitcnt vmcnt(29)
  v_lshlrev_b32 v92, 16, v250
  v_and_b32 v93, 0xffff0000, v250
  v_lshlrev_b32_e64 v94, 16, v251
  buffer_load_dwordx4 v[228:231], v141, s[20:23], s95 offen offset:256 sc1
  v_and_b32 v95, 0xffff0000, v251
  s_waitcnt vmcnt(29)
  v_lshlrev_b32 v96, 16, v252
  v_and_b32 v97, 0xffff0000, v252
  v_lshlrev_b32_e64 v98, 16, v253
  v_and_b32 v99, 0xffff0000, v253
  buffer_load_dwordx4 v[232:235], v142, s[20:23], s95 offen offset:0 sc1
  buffer_load_dwordx4 v[236:239], v142, s[20:23], s95 offen offset:256 sc1
  s_add_u32 s95, s95, 16384
  buffer_load_dwordx4 v[144:147], v141, s[20:23], s95 offen offset:0 sc1
  s_waitcnt vmcnt(16)
  v_mfma_f32_16x16x32_bf16 v[0:3], a[0:3], v[192:195], v[80:83]
  v_cmp_ne_u32 vcc, s77, v189
  s_mov_b32 s97, 0
  s_cbranch_vccz Lpoll_800013_ok
Lpoll_800013:
  s_sleep 1
  buffer_load_dword v189, v188, s[20:23], 0 offen sc1
  s_add_u32 s97, s97, 1
  s_waitcnt vmcnt(0)
  v_cmp_ne_u32 vcc, s77, v189
  s_cmp_gt_u32 s97, 32768
  s_cbranch_scc1 Lpoll_800013_ok
  s_cbranch_vccnz Lpoll_800013
Lpoll_800013_ok:
  v_mfma_f32_16x16x32_bf16 v[16:19], a[4:7], v[192:195], v[84:87]
  s_mul_i32 s71, s86, 81920
  s_add_u32 s96, s96, s71
  v_mfma_f32_16x16x32_bf16 v[32:35], a[8:11], v[192:195], v[88:91]
  s_lshl_b32 s71, s3, 6
  v_add_u32_e64 v122, s71, v190
  v_mfma_f32_16x16x32_bf16 v[48:51], a[12:15], v[192:195], v[92:95]
  s_add_u32 s71, s71, 256
  v_mul_u32_u24 v123, 3277, v122
  v_mfma_f32_16x16x32_bf16 v[64:67], a[16:19], v[192:195], v[96:99]
  v_lshrrev_b32_e64 v123, 16, v123
  v_mul_u32_u24 v124, 20, v123
  s_waitcnt vmcnt(15)
  v_mfma_f32_16x16x32_bf16 v[4:7], a[0:3], v[196:199], v[80:83]
  v_sub_u32_e64 v122, v122, v124
  v_mul_u32_u24 v124, 336, v123
  v_mfma_f32_16x16x32_bf16 v[20:23], a[4:7], v[196:199], v[84:87]
  v_lshl_add_u32 v115, v122, 4, v124
  v_mul_u32_u24 v124, 1280, v123
  v_mfma_f32_16x16x32_bf16 v[36:39], a[8:11], v[196:199], v[88:91]
  v_lshl_add_u32 v110, v122, 3, v124
  buffer_load_dwordx2 v[100:101], v110, s[8:11], s96 offen
  v_mfma_f32_16x16x32_bf16 v[52:55], a[12:15], v[196:199], v[92:95]
  v_add_u32_e64 v122, s71, v190
  s_add_u32 s71, s71, 256
  v_mfma_f32_16x16x32_bf16 v[68:71], a[16:19], v[196:199], v[96:99]
  v_mul_u32_u24 v123, 3277, v122
  v_lshrrev_b32 v123, 16, v123
  s_waitcnt vmcnt(15)
  v_mfma_f32_16x16x32_bf16 v[8:11], a[0:3], v[200:203], v[80:83]
  v_mul_u32_u24 v124, 20, v123
  v_sub_u32 v122, v122, v124
  v_mfma_f32_16x16x32_bf16 v[24:27], a[4:7], v[200:203], v[84:87]
  v_mul_u32_u24 v124, 336, v123
  v_lshl_add_u32 v116, v122, 4, v124
  v_mfma_f32_16x16x32_bf16 v[40:43], a[8:11], v[200:203], v[88:91]
  v_mul_u32_u24 v124, 1280, v123
  v_lshl_add_u32 v111, v122, 3, v124
  v_mfma_f32_16x16x32_bf16 v[56:59], a[12:15], v[200:203], v[92:95]
  buffer_load_dwordx2 v[102:103], v111, s[8:11], s96 offen
  v_add_u32_e64 v122, s71, v190
  v_mfma_f32_16x16x32_bf16 v[72:75], a[16:19], v[200:203], v[96:99]
  s_add_u32 s71, s71, 256
  v_mul_u32_u24 v123, 3277, v122
  s_waitcnt vmcnt(15)
  v_mfma_f32_16x16x32_bf16 v[12:15], a[0:3], v[204:207], v[80:83]
  v_lshrrev_b32 v123, 16, v123
  v_mul_u32_u24_e64 v124, 20, v123
  v_mfma_f32_16x16x32_bf16 v[28:31], a[4:7], v[204:207], v[84:87]
  v_sub_u32_e64 v122, v122, v124
  v_mul_u32_u24 v124, 336, v123
  v_mfma_f32_16x16x32_bf16 v[44:47], a[8:11], v[204:207], v[88:91]
  v_lshl_add_u32 v117, v122, 4, v124
  v_mul_u32_u24 v124, 1280, v123
  v_mfma_f32_16x16x32_bf16 v[60:63], a[12:15], v[204:207], v[92:95]
  v_lshl_add_u32 v112, v122, 3, v124
  buffer_load_dwordx2 v[104:105], v112, s[8:11], s96 offen
  v_mfma_f32_16x16x32_bf16 v[76:79], a[16:19], v[204:207], v[96:99]
  v_add_u32_e64 v122, s71, v190
  s_add_u32 s71, s71, 256
  v_mul_u32_u24 v123, 3277, v122
  v_lshrrev_b32 v123, 16, v123
  v_mul_u32_u24 v124, 20, v123
  v_sub_u32_e64 v122, v122, v124
  v_mul_u32_u24 v124, 336, v123
  v_lshl_add_u32 v118, v122, 4, v124
  v_mul_u32_u24 v124, 1280, v123
  v_lshl_add_u32 v113, v122, 3, v124
  buffer_load_dwordx2 v[106:107], v113, s[8:11], s96 offen
  v_add_u32_e64 v122, s71, v190
  s_add_u32 s71, s71, 256
  v_mul_u32_u24 v123, 3277, v122
  v_lshrrev_b32 v123, 16, v123
  v_mul_u32_u24 v124, 20, v123
  v_sub_u32_e64 v122, v122, v124
  v_mul_u32_u24 v124, 336, v123
  v_lshl_add_u32 v119, v122, 4, v124
  v_mul_u32_u24 v124, 1280, v123
  v_lshl_add_u32 v114, v122, 3, v124
  buffer_load_dwordx2 v[108:109], v114, s[8:11], s96 offen
  s_waitcnt vmcnt(17)
  v_mfma_f32_16x16x32_bf16 v[0:3], a[20:23], v[208:211], v[0:3]
  v_add_u32 v125, s92, v171
  v_mfma_f32_16x16x32_bf16 v[16:19], a[24:27], v[208:211], v[16:19]
  v_add_u32 v125, 65536, v125
  v_add_u32 v126, 65536, v125
  v_mfma_f32_16x16x32_bf16 v[32:35], a[28:31], v[208:211], v[32:35]
  ds_read_b128 a[0:3], v126 offset:16384
  ds_read_b128 a[4:7], v126 offset:17408
  v_mfma_f32_16x16x32_bf16 v[48:51], a[32:35], v[208:211], v[48:51]
  ds_read_b128 a[8:11], v126 offset:24576
  ds_read_b128 a[12:15], v126 offset:25600
  v_mfma_f32_16x16x32_bf16 v[64:67], a[36:39], v[208:211], v[64:67]
  ds_read_b128 a[16:19], v125 offset:40960
  s_waitcnt vmcnt(16)
  v_mfma_f32_16x16x32_bf16 v[4:7], a[20:23], v[212:215], v[4:7]
  v_mfma_f32_16x16x32_bf16 v[20:23], a[24:27], v[212:215], v[20:23]
  v_mfma_f32_16x16x32_bf16 v[36:39], a[28:31], v[212:215], v[36:39]
  v_mfma_f32_16x16x32_bf16 v[52:55], a[32:35], v[212:215], v[52:55]
  v_mfma_f32_16x16x32_bf16 v[68:71], a[36:39], v[212:215], v[68:71]
  s_waitcnt vmcnt(15)
  v_mfma_f32_16x16x32_bf16 v[8:11], a[20:23], v[216:219], v[8:11]
  buffer_load_dwordx4 v[148:151], v141, s[20:23], s95 offen offset:256 sc1
  v_mfma_f32_16x16x32_bf16 v[24:27], a[24:27], v[216:219], v[24:27]
  v_mfma_f32_16x16x32_bf16 v[40:43], a[28:31], v[216:219], v[40:43]
  v_mfma_f32_16x16x32_bf16 v[56:59], a[32:35], v[216:219], v[56:59]
  v_mfma_f32_16x16x32_bf16 v[72:75], a[36:39], v[216:219], v[72:75]
  buffer_load_dwordx4 v[152:155], v142, s[20:23], s95 offen offset:0 sc1
  buffer_load_dwordx4 v[156:159], v142, s[20:23], s95 offen offset:256 sc1
  s_add_u32 s95, s95, 16384
  buffer_load_dwordx4 v[172:175], v141, s[20:23], s95 offen offset:0 sc1
  s_waitcnt vmcnt(16)
  v_mfma_f32_16x16x32_bf16 v[12:15], a[20:23], v[220:223], v[12:15]
  v_mfma_f32_16x16x32_bf16 v[28:31], a[24:27], v[220:223], v[28:31]
  v_mfma_f32_16x16x32_bf16 v[44:47], a[28:31], v[220:223], v[44:47]
  v_mfma_f32_16x16x32_bf16 v[60:63], a[32:35], v[220:223], v[60:63]
  v_mfma_f32_16x16x32_bf16 v[76:79], a[36:39], v[220:223], v[76:79]
  buffer_load_dwordx4 v[176:179], v141, s[20:23], s95 offen offset:256 sc1
  buffer_load_dwordx4 v[180:183], v142, s[20:23], s95 offen offset:0 sc1
  buffer_load_dwordx4 v[184:187], v142, s[20:23], s95 offen offset:256 sc1
  s_add_u32 s95, s95, 16384
  buffer_load_dwordx4 v[192:195], v141, s[20:23], s95 offen offset:0 sc1
  buffer_load_dwordx4 v[196:199], v141, s[20:23], s95 offen offset:256 sc1
  buffer_load_dwordx4 v[200:203], v142, s[20:23], s95 offen offset:0 sc1
  buffer_load_dwordx4 v[204:207], v142, s[20:23], s95 offen offset:256 sc1
  s_waitcnt vmcnt(20)
  v_mfma_f32_16x16x32_bf16 v[0:3], a[40:43], v[224:227], v[0:3]
  ds_read_b128 a[20:23], v125 offset:41984
  v_mfma_f32_16x16x32_bf16 v[16:19], a[44:47], v[224:227], v[16:19]
  ds_read_b128 a[24:27], v125 offset:49152
  ds_read_b128 a[28:31], v125 offset:50176
  v_mfma_f32_16x16x32_bf16 v[32:35], a[48:51], v[224:227], v[32:35]
  ds_read_b128 a[32:35], v125 offset:57344
  ds_read_b128 a[36:39], v125 offset:58368
  v_mfma_f32_16x16x32_bf16 v[48:51], a[52:55], v[224:227], v[48:51]
  v_mfma_f32_16x16x32_bf16 v[64:67], a[56:59], v[224:227], v[64:67]
  s_add_u32 s100, s99, 655360
  v_mov_b32_e64 v189, s77
  s_mov_b64 exec, 1
  buffer_store_dword v189, off, s[20:23], s100 sc1
  s_mov_b64 exec, -1
  s_waitcnt vmcnt(20)
  v_mfma_f32_16x16x32_bf16 v[4:7], a[40:43], v[228:231], v[4:7]
  v_mfma_f32_16x16x32_bf16 v[20:23], a[44:47], v[228:231], v[20:23]
  v_mfma_f32_16x16x32_bf16 v[36:39], a[48:51], v[228:231], v[36:39]
  v_mfma_f32_16x16x32_bf16 v[52:55], a[52:55], v[228:231], v[52:55]
  s_add_u32 s95, s95, 16384
  buffer_load_dwordx4 v[208:211], v141, s[20:23], s95 offen offset:0 sc1
  v_mfma_f32_16x16x32_bf16 v[68:71], a[56:59], v[228:231], v[68:71]
  s_waitcnt vmcnt(20)
  v_mfma_f32_16x16x32_bf16 v[8:11], a[40:43], v[232:235], v[8:11]
  v_mfma_f32_16x16x32_bf16 v[24:27], a[44:47], v[232:235], v[24:27]
  v_mfma_f32_16x16x32_bf16 v[40:43], a[48:51], v[232:235], v[40:43]
  v_mfma_f32_16x16x32_bf16 v[56:59], a[52:55], v[232:235], v[56:59]
  v_mfma_f32_16x16x32_bf16 v[72:75], a[56:59], v[232:235], v[72:75]
  buffer_load_dwordx4 v[212:215], v141, s[20:23], s95 offen offset:256 sc1
  s_waitcnt vmcnt(20)
  v_mfma_f32_16x16x32_bf16 v[12:15], a[40:43], v[236:239], v[12:15]
  v_mfma_f32_16x16x32_bf16 v[28:31], a[44:47], v[236:239], v[28:31]
  v_mfma_f32_16x16x32_bf16 v[44:47], a[48:51], v[236:239], v[44:47]
  v_mfma_f32_16x16x32_bf16 v[60:63], a[52:55], v[236:239], v[60:63]
  v_mfma_f32_16x16x32_bf16 v[76:79], a[56:59], v[236:239], v[76:79]
  s_waitcnt vmcnt(19)
  v_mfma_f32_16x16x32_bf16 v[0:3], a[60:63], v[144:147], v[0:3]
  buffer_load_dwordx4 v[216:219], v142, s[20:23], s95 offen offset:0 sc1
  v_mfma_f32_16x16x32_bf16 v[16:19], a[64:67], v[144:147], v[16:19]
  ds_read_b128 a[40:43], v125 offset:0
  ds_read_b128 a[44:47], v125 offset:1024
  v_mfma_f32_16x16x32_bf16 v[32:35], a[68:71], v[144:147], v[32:35]
  ds_read_b128 a[48:51], v125 offset:8192
  ds_read_b128 a[52:55], v125 offset:9216
  v_mfma_f32_16x16x32_bf16 v[48:51], a[72:75], v[144:147], v[48:51]
  ds_read_b128 a[56:59], v125 offset:16384
  v_mfma_f32_16x16x32_bf16 v[64:67], a[76:79], v[144:147], v[64:67]
  s_waitcnt vmcnt(14)
  v_mfma_f32_16x16x32_bf16 v[4:7], a[60:63], v[148:151], v[4:7]
  buffer_load_dwordx4 v[220:223], v142, s[20:23], s95 offen offset:256 sc1
  v_mfma_f32_16x16x32_bf16 v[20:23], a[64:67], v[148:151], v[20:23]
  v_mfma_f32_16x16x32_bf16 v[36:39], a[68:71], v[148:151], v[36:39]
  v_mfma_f32_16x16x32_bf16 v[52:55], a[72:75], v[148:151], v[52:55]
  v_mfma_f32_16x16x32_bf16 v[68:71], a[76:79], v[148:151], v[68:71]
  s_waitcnt vmcnt(14)
  v_mfma_f32_16x16x32_bf16 v[8:11], a[60:63], v[152:155], v[8:11]
  s_add_u32 s95, s95, 4294873088
  buffer_load_dwordx4 v[224:227], v141, s[20:23], s95 offen offset:0 sc1
  v_mfma_f32_16x16x32_bf16 v[24:27], a[64:67], v[152:155], v[24:27]
  v_mfma_f32_16x16x32_bf16 v[40:43], a[68:71], v[152:155], v[40:43]
  v_mfma_f32_16x16x32_bf16 v[56:59], a[72:75], v[152:155], v[56:59]
  v_mfma_f32_16x16x32_bf16 v[72:75], a[76:79], v[152:155], v[72:75]
  s_waitcnt vmcnt(14)
  v_mfma_f32_16x16x32_bf16 v[12:15], a[60:63], v[156:159], v[12:15]
  v_mfma_f32_16x16x32_bf16 v[28:31], a[64:67], v[156:159], v[28:31]
  buffer_load_dwordx4 v[228:231], v141, s[20:23], s95 offen offset:256 sc1
  v_mfma_f32_16x16x32_bf16 v[44:47], a[68:71], v[156:159], v[44:47]
  v_mfma_f32_16x16x32_bf16 v[60:63], a[72:75], v[156:159], v[60:63]
  v_mfma_f32_16x16x32_bf16 v[76:79], a[76:79], v[156:159], v[76:79]
  s_waitcnt vmcnt(14)
  v_mfma_f32_16x16x32_bf16 v[0:3], a[80:83], v[172:175], v[0:3]
  ds_read_b128 a[60:63], v125 offset:17408
  v_mfma_f32_16x16x32_bf16 v[16:19], a[84:87], v[172:175], v[16:19]
  ds_read_b128 a[64:67], v125 offset:24576
  ds_read_b128 a[68:71], v125 offset:25600
  v_mfma_f32_16x16x32_bf16 v[32:35], a[88:91], v[172:175], v[32:35]
  buffer_load_dwordx4 v[232:235], v142, s[20:23], s95 offen offset:0 sc1
  ds_read_b128 a[72:75], v126 offset:0
  v_mfma_f32_16x16x32_bf16 v[48:51], a[92:95], v[172:175], v[48:51]
  ds_read_b128 a[76:79], v126 offset:1024
  v_mfma_f32_16x16x32_bf16 v[64:67], a[96:99], v[172:175], v[64:67]
  s_waitcnt vmcnt(14)
  v_mfma_f32_16x16x32_bf16 v[4:7], a[80:83], v[176:179], v[4:7]
  v_mfma_f32_16x16x32_bf16 v[20:23], a[84:87], v[176:179], v[20:23]
  v_mfma_f32_16x16x32_bf16 v[36:39], a[88:91], v[176:179], v[36:39]
  buffer_load_dwordx4 v[236:239], v142, s[20:23], s95 offen offset:256 sc1
  v_mfma_f32_16x16x32_bf16 v[52:55], a[92:95], v[176:179], v[52:55]
  v_mfma_f32_16x16x32_bf16 v[68:71], a[96:99], v[176:179], v[68:71]
  s_waitcnt vmcnt(14)
  v_mfma_f32_16x16x32_bf16 v[8:11], a[80:83], v[180:183], v[8:11]
  v_mfma_f32_16x16x32_bf16 v[24:27], a[84:87], v[180:183], v[24:27]
  v_mfma_f32_16x16x32_bf16 v[40:43], a[88:91], v[180:183], v[40:43]
  v_mfma_f32_16x16x32_bf16 v[56:59], a[92:95], v[180:183], v[56:59]
  s_add_u32 s95, s95, 16384
  buffer_load_dwordx4 v[144:147], v141, s[20:23], s95 offen offset:0 sc1
  v_mfma_f32_16x16x32_bf16 v[72:75], a[96:99], v[180:183], v[72:75]
  s_waitcnt vmcnt(14)
  v_mfma_f32_16x16x32_bf16 v[12:15], a[80:83], v[184:187], v[12:15]
  v_mfma_f32_16x16x32_bf16 v[28:31], a[84:87], v[184:187], v[28:31]
  v_mfma_f32_16x16x32_bf16 v[44:47], a[88:91], v[184:187], v[44:47]
  v_mfma_f32_16x16x32_bf16 v[60:63], a[92:95], v[184:187], v[60:63]
  buffer_load_dwordx4 v[148:151], v141, s[20:23], s95 offen offset:256 sc1
  v_mfma_f32_16x16x32_bf16 v[76:79], a[96:99], v[184:187], v[76:79]
  s_waitcnt vmcnt(14)
  v_mfma_f32_16x16x32_bf16 v[0:3], a[100:103], v[192:195], v[0:3]
  s_lshr_b32 s72, s92, 1
  v_mfma_f32_16x16x32_bf16 v[16:19], a[104:107], v[192:195], v[16:19]
  s_add_u32 s72, s72, 49152
  v_add_u32 v127, s72, v171
  v_mfma_f32_16x16x32_bf16 v[32:35], a[108:111], v[192:195], v[32:35]
  ds_read_b128 a[80:83], v126 offset:8192
  ds_read_b128 a[84:87], v126 offset:9216
  v_mfma_f32_16x16x32_bf16 v[48:51], a[112:115], v[192:195], v[48:51]
  buffer_load_dwordx4 v[152:155], v142, s[20:23], s95 offen offset:0 sc1
  ds_read_b128 a[88:91], v127 offset:9216
  v_mfma_f32_16x16x32_bf16 v[64:67], a[116:119], v[192:195], v[64:67]
  ds_read_b128 a[92:95], v127 offset:51200
  s_waitcnt vmcnt(14)
  v_mfma_f32_16x16x32_bf16 v[4:7], a[100:103], v[196:199], v[4:7]
  v_mfma_f32_16x16x32_bf16 v[20:23], a[104:107], v[196:199], v[20:23]
  v_mfma_f32_16x16x32_bf16 v[36:39], a[108:111], v[196:199], v[36:39]
  v_mfma_f32_16x16x32_bf16 v[52:55], a[112:115], v[196:199], v[52:55]
  v_mfma_f32_16x16x32_bf16 v[68:71], a[116:119], v[196:199], v[68:71]
  buffer_load_dwordx4 v[156:159], v142, s[20:23], s95 offen offset:256 sc1
  s_waitcnt vmcnt(14)
  v_mfma_f32_16x16x32_bf16 v[8:11], a[100:103], v[200:203], v[8:11]
  v_mfma_f32_16x16x32_bf16 v[24:27], a[104:107], v[200:203], v[24:27]
  v_mfma_f32_16x16x32_bf16 v[40:43], a[108:111], v[200:203], v[40:43]
  v_mfma_f32_16x16x32_bf16 v[56:59], a[112:115], v[200:203], v[56:59]
  v_mfma_f32_16x16x32_bf16 v[72:75], a[116:119], v[200:203], v[72:75]
  s_waitcnt vmcnt(13)
  v_mfma_f32_16x16x32_bf16 v[12:15], a[100:103], v[204:207], v[12:15]
  s_add_u32 s95, s95, 16384
  buffer_load_dwordx4 v[172:175], v141, s[20:23], s95 offen offset:0 sc1
  v_mfma_f32_16x16x32_bf16 v[28:31], a[104:107], v[204:207], v[28:31]
  v_mfma_f32_16x16x32_bf16 v[44:47], a[108:111], v[204:207], v[44:47]
  v_mfma_f32_16x16x32_bf16 v[60:63], a[112:115], v[204:207], v[60:63]
  v_mfma_f32_16x16x32_bf16 v[76:79], a[116:119], v[204:207], v[76:79]
  s_waitcnt vmcnt(12)
  v_mfma_f32_16x16x32_bf16 v[0:3], a[120:123], v[208:211], v[0:3]
  buffer_load_dwordx4 v[176:179], v141, s[20:23], s95 offen offset:256 sc1
  v_lshlrev_b32_e64 v80, 16, v100
  v_mfma_f32_16x16x32_bf16 v[16:19], a[124:127], v[208:211], v[16:19]
  v_and_b32 v81, 0xffff0000, v100
  v_lshlrev_b32_e64 v82, 16, v101
  v_mfma_f32_16x16x32_bf16 v[32:35], a[128:131], v[208:211], v[32:35]
  v_and_b32 v83, 0xffff0000, v101
  v_lshlrev_b32_e64 v84, 16, v102
  v_mfma_f32_16x16x32_bf16 v[48:51], a[132:135], v[208:211], v[48:51]
  v_and_b32 v85, 0xffff0000, v102
  v_lshlrev_b32_e64 v86, 16, v103
  v_mfma_f32_16x16x32_bf16 v[64:67], a[136:139], v[208:211], v[64:67]
  buffer_load_dwordx4 v[180:183], v142, s[20:23], s95 offen offset:0 sc1
  v_and_b32 v87, 0xffff0000, v103
  s_waitcnt vmcnt(13)
  v_mfma_f32_16x16x32_bf16 v[4:7], a[120:123], v[212:215], v[4:7]
  v_lshlrev_b32 v88, 16, v104
  v_mfma_f32_16x16x32_bf16 v[20:23], a[124:127], v[212:215], v[20:23]
  v_and_b32 v89, 0xffff0000, v104
  v_lshlrev_b32_e64 v90, 16, v105
  v_mfma_f32_16x16x32_bf16 v[36:39], a[128:131], v[212:215], v[36:39]
  v_and_b32 v91, 0xffff0000, v105
  v_lshlrev_b32_e64 v92, 16, v106
  v_mfma_f32_16x16x32_bf16 v[52:55], a[132:135], v[212:215], v[52:55]
  v_and_b32 v93, 0xffff0000, v106
  v_lshlrev_b32_e64 v94, 16, v107
  v_mfma_f32_16x16x32_bf16 v[68:71], a[136:139], v[212:215], v[68:71]
  buffer_load_dwordx4 v[184:187], v142, s[20:23], s95 offen offset:256 sc1
  v_and_b32 v95, 0xffff0000, v107
  s_waitcnt vmcnt(13)
  v_mfma_f32_16x16x32_bf16 v[8:11], a[120:123], v[216:219], v[8:11]
  v_lshlrev_b32 v96, 16, v108
  v_mfma_f32_16x16x32_bf16 v[24:27], a[124:127], v[216:219], v[24:27]
  v_and_b32 v97, 0xffff0000, v108
  v_lshlrev_b32 v98, 16, v109
  v_mfma_f32_16x16x32_bf16 v[40:43], a[128:131], v[216:219], v[40:43]
  v_and_b32 v99, 0xffff0000, v109
  v_mfma_f32_16x16x32_bf16 v[56:59], a[132:135], v[216:219], v[56:59]
  v_mfma_f32_16x16x32_bf16 v[72:75], a[136:139], v[216:219], v[72:75]
  s_add_u32 s95, s95, 16384
  buffer_load_dwordx4 v[192:195], v141, s[20:23], s95 offen offset:0 sc1
  s_waitcnt vmcnt(13)
  v_mfma_f32_16x16x32_bf16 v[12:15], a[120:123], v[220:223], v[12:15]
  v_mfma_f32_16x16x32_bf16 v[28:31], a[124:127], v[220:223], v[28:31]
  v_mfma_f32_16x16x32_bf16 v[44:47], a[128:131], v[220:223], v[44:47]
  v_mfma_f32_16x16x32_bf16 v[60:63], a[132:135], v[220:223], v[60:63]
  v_mfma_f32_16x16x32_bf16 v[76:79], a[136:139], v[220:223], v[76:79]
  s_waitcnt vmcnt(12)
  v_mfma_f32_16x16x32_bf16 v[0:3], a[140:143], v[224:227], v[0:3]
  buffer_load_dwordx4 v[196:199], v141, s[20:23], s95 offen offset:256 sc1
  v_mfma_f32_16x16x32_bf16 v[16:19], a[144:147], v[224:227], v[16:19]
  v_mfma_f32_16x16x32_bf16 v[32:35], a[148:151], v[224:227], v[32:35]
  v_mfma_f32_16x16x32_bf16 v[48:51], a[152:155], v[224:227], v[48:51]
  v_mfma_f32_16x16x32_bf16 v[64:67], a[156:159], v[224:227], v[64:67]
  s_waitcnt vmcnt(12)
  v_mfma_f32_16x16x32_bf16 v[4:7], a[140:143], v[228:231], v[4:7]
  buffer_load_dwordx4 v[200:203], v142, s[20:23], s95 offen offset:0 sc1
  v_mfma_f32_16x16x32_bf16 v[20:23], a[144:147], v[228:231], v[20:23]
  v_mfma_f32_16x16x32_bf16 v[36:39], a[148:151], v[228:231], v[36:39]
  v_mfma_f32_16x16x32_bf16 v[52:55], a[152:155], v[228:231], v[52:55]
  v_mfma_f32_16x16x32_bf16 v[68:71], a[156:159], v[228:231], v[68:71]
  s_waitcnt vmcnt(12)
  v_mfma_f32_16x16x32_bf16 v[8:11], a[140:143], v[232:235], v[8:11]
  v_mfma_f32_16x16x32_bf16 v[24:27], a[144:147], v[232:235], v[24:27]
  buffer_load_dwordx4 v[204:207], v142, s[20:23], s95 offen offset:256 sc1
  v_mfma_f32_16x16x32_bf16 v[40:43], a[148:151], v[232:235], v[40:43]
  v_mfma_f32_16x16x32_bf16 v[56:59], a[152:155], v[232:235], v[56:59]
  v_mfma_f32_16x16x32_bf16 v[72:75], a[156:159], v[232:235], v[72:75]
  s_waitcnt vmcnt(12)
  v_mfma_f32_16x16x32_bf16 v[12:15], a[140:143], v[236:239], v[12:15]
  v_mfma_f32_16x16x32_bf16 v[28:31], a[144:147], v[236:239], v[28:31]
  v_mfma_f32_16x16x32_bf16 v[44:47], a[148:151], v[236:239], v[44:47]
  s_add_u32 s95, s95, 16384
  buffer_load_dwordx4 v[208:211], v141, s[20:23], s95 offen offset:0 sc1
  v_mfma_f32_16x16x32_bf16 v[60:63], a[152:155], v[236:239], v[60:63]
  v_mfma_f32_16x16x32_bf16 v[76:79], a[156:159], v[236:239], v[76:79]
  s_waitcnt vmcnt(12)
  v_mfma_f32_16x16x32_bf16 v[0:3], a[160:163], v[144:147], v[0:3]
  s_lshl_b32 s72, s86, 12
  s_add_u32 s72, s72, 655360
  v_mfma_f32_16x16x32_bf16 v[16:19], a[164:167], v[144:147], v[16:19]
  v_and_b32_e64 v188, 31, v190
  v_lshl_add_u32 v188, v188, 7, s72
  v_mfma_f32_16x16x32_bf16 v[32:35], a[168:171], v[144:147], v[32:35]
  buffer_load_dword v189, v188, s[20:23], 0 offen sc1
  v_and_b32_e64 v122, 15, v190
  v_mfma_f32_16x16x32_bf16 v[48:51], a[172:175], v[144:147], v[48:51]
  v_mul_u32_u24 v122, 336, v122
  v_lshrrev_b32_e64 v123, 4, v190
  v_mfma_f32_16x16x32_bf16 v[64:67], a[176:179], v[144:147], v[64:67]
  v_lshl_add_u32 v122, v123, 4, v122
  s_mul_i32 s65, s3, 21504
  s_waitcnt vmcnt(12)
  v_mfma_f32_16x16x32_bf16 v[4:7], a[160:163], v[148:151], v[4:7]
  s_add_u32 s65, s65, 0
  v_add_u32 v122, s65, v122
  v_mfma_f32_16x16x32_bf16 v[20:23], a[164:167], v[148:151], v[20:23]
  v_mfma_f32_16x16x32_bf16 v[36:39], a[168:171], v[148:151], v[36:39]
  buffer_load_dwordx4 v[212:215], v141, s[20:23], s95 offen offset:256 sc1
  v_mfma_f32_16x16x32_bf16 v[52:55], a[172:175], v[148:151], v[52:55]
  v_mfma_f32_16x16x32_bf16 v[68:71], a[176:179], v[148:151], v[68:71]
  s_waitcnt vmcnt(12)
  v_mfma_f32_16x16x32_bf16 v[8:11], a[160:163], v[152:155], v[8:11]
  v_mfma_f32_16x16x32_bf16 v[24:27], a[164:167], v[152:155], v[24:27]
  v_mfma_f32_16x16x32_bf16 v[40:43], a[168:171], v[152:155], v[40:43]
  v_mfma_f32_16x16x32_bf16 v[56:59], a[172:175], v[152:155], v[56:59]
  buffer_load_dwordx4 v[216:219], v142, s[20:23], s95 offen offset:0 sc1
  v_mfma_f32_16x16x32_bf16 v[72:75], a[176:179], v[152:155], v[72:75]
  s_waitcnt vmcnt(12)
  v_mfma_f32_16x16x32_bf16 v[12:15], a[160:163], v[156:159], v[12:15]
  v_mfma_f32_16x16x32_bf16 v[28:31], a[164:167], v[156:159], v[28:31]
  v_mfma_f32_16x16x32_bf16 v[44:47], a[168:171], v[156:159], v[44:47]
  v_mfma_f32_16x16x32_bf16 v[60:63], a[172:175], v[156:159], v[60:63]
  v_mfma_f32_16x16x32_bf16 v[76:79], a[176:179], v[156:159], v[76:79]
  buffer_load_dwordx4 v[220:223], v142, s[20:23], s95 offen offset:256 sc1
  s_waitcnt vmcnt(12)
  v_mfma_f32_16x16x32_bf16 v[0:3], a[180:183], v[172:175], v[0:3]
  v_mfma_f32_16x16x32_bf16 v[16:19], a[184:187], v[172:175], v[16:19]
  v_mfma_f32_16x16x32_bf16 v[32:35], a[188:191], v[172:175], v[32:35]
  v_mfma_f32_16x16x32_bf16 v[48:51], a[192:195], v[172:175], v[48:51]
  v_mfma_f32_16x16x32_bf16 v[64:67], a[196:199], v[172:175], v[64:67]
  s_add_u32 s4, s52, 2707456
  buffer_load_dwordx4 a[96:99], v171, s[20:23], s4 offen sc1
  s_waitcnt vmcnt(12)
  v_mfma_f32_16x16x32_bf16 v[4:7], a[180:183], v[176:179], v[4:7]
  v_mfma_f32_16x16x32_bf16 v[20:23], a[184:187], v[176:179], v[20:23]
  v_mfma_f32_16x16x32_bf16 v[36:39], a[188:191], v[176:179], v[36:39]
  v_mfma_f32_16x16x32_bf16 v[52:55], a[192:195], v[176:179], v[52:55]
  v_mfma_f32_16x16x32_bf16 v[68:71], a[196:199], v[176:179], v[68:71]
  s_waitcnt vmcnt(11)
  v_mfma_f32_16x16x32_bf16 v[8:11], a[180:183], v[180:183], v[8:11]
  s_add_u32 s95, s95, 16384
  buffer_load_dwordx4 v[224:227], v141, s[20:23], s95 offen offset:0 sc1
  v_mfma_f32_16x16x32_bf16 v[24:27], a[184:187], v[180:183], v[24:27]
  v_mfma_f32_16x16x32_bf16 v[40:43], a[188:191], v[180:183], v[40:43]
  v_mfma_f32_16x16x32_bf16 v[56:59], a[192:195], v[180:183], v[56:59]
  v_mfma_f32_16x16x32_bf16 v[72:75], a[196:199], v[180:183], v[72:75]
  s_waitcnt vmcnt(11)
  v_mfma_f32_16x16x32_bf16 v[12:15], a[180:183], v[184:187], v[12:15]
  v_mfma_f32_16x16x32_bf16 v[28:31], a[184:187], v[184:187], v[28:31]
  buffer_load_dwordx4 v[228:231], v141, s[20:23], s95 offen offset:256 sc1
  v_mfma_f32_16x16x32_bf16 v[44:47], a[188:191], v[184:187], v[44:47]
  v_mfma_f32_16x16x32_bf16 v[60:63], a[192:195], v[184:187], v[60:63]
  v_mfma_f32_16x16x32_bf16 v[76:79], a[196:199], v[184:187], v[76:79]
  s_waitcnt vmcnt(11)
  v_mfma_f32_16x16x32_bf16 v[0:3], a[200:203], v[192:195], v[0:3]
  v_mfma_f32_16x16x32_bf16 v[16:19], a[204:207], v[192:195], v[16:19]
  buffer_load_dwordx4 v[232:235], v142, s[20:23], s95 offen offset:0 sc1
  v_mfma_f32_16x16x32_bf16 v[32:35], a[208:211], v[192:195], v[32:35]
  v_mfma_f32_16x16x32_bf16 v[48:51], a[212:215], v[192:195], v[48:51]
  v_mfma_f32_16x16x32_bf16 v[64:67], a[216:219], v[192:195], v[64:67]
  s_waitcnt vmcnt(11)
  v_mfma_f32_16x16x32_bf16 v[4:7], a[200:203], v[196:199], v[4:7]
  v_mfma_f32_16x16x32_bf16 v[20:23], a[204:207], v[196:199], v[20:23]
  v_mfma_f32_16x16x32_bf16 v[36:39], a[208:211], v[196:199], v[36:39]
  buffer_load_dwordx4 v[236:239], v142, s[20:23], s95 offen offset:256 sc1
  v_mfma_f32_16x16x32_bf16 v[52:55], a[212:215], v[196:199], v[52:55]
  v_mfma_f32_16x16x32_bf16 v[68:71], a[216:219], v[196:199], v[68:71]
  s_waitcnt vmcnt(11)
  v_mfma_f32_16x16x32_bf16 v[8:11], a[200:203], v[200:203], v[8:11]
  v_mfma_f32_16x16x32_bf16 v[24:27], a[204:207], v[200:203], v[24:27]
  v_mfma_f32_16x16x32_bf16 v[40:43], a[208:211], v[200:203], v[40:43]
  v_mfma_f32_16x16x32_bf16 v[56:59], a[212:215], v[200:203], v[56:59]
  s_add_u32 s4, s52, 2867200
  buffer_load_dwordx4 a[100:103], v171, s[20:23], s4 offen offset:0 sc1
  v_mfma_f32_16x16x32_bf16 v[72:75], a[216:219], v[200:203], v[72:75]
  s_waitcnt vmcnt(11)
  v_mfma_f32_16x16x32_bf16 v[12:15], a[200:203], v[204:207], v[12:15]
  v_mfma_f32_16x16x32_bf16 v[28:31], a[204:207], v[204:207], v[28:31]
  v_mfma_f32_16x16x32_bf16 v[44:47], a[208:211], v[204:207], v[44:47]
  v_mfma_f32_16x16x32_bf16 v[60:63], a[212:215], v[204:207], v[60:63]
  v_mfma_f32_16x16x32_bf16 v[76:79], a[216:219], v[204:207], v[76:79]
  buffer_load_dwordx4 a[104:107], v171, s[20:23], s4 offen offset:1024 sc1
  s_waitcnt vmcnt(11)
  v_mfma_f32_16x16x32_bf16 v[0:3], a[220:223], v[208:211], v[0:3]
  buffer_load_dwordx4 a[108:111], v171, s[20:23], s4 offen offset:2048 sc1
  buffer_load_dwordx4 a[112:115], v171, s[20:23], s4 offen offset:3072 sc1
  s_waitcnt vmcnt(12)
  v_cmp_ne_u32_e64 vcc, s77, v189
  s_mov_b32 s97, 0
  s_cbranch_vccz Lpoll_811014_ok
Lpoll_811014:
  s_sleep 1
  buffer_load_dword v189, v188, s[20:23], 0 offen sc1
  s_add_u32 s97, s97, 1
  s_waitcnt vmcnt(0)
  v_cmp_ne_u32 vcc, s77, v189
  s_cmp_gt_u32 s97, 32768
  s_cbranch_scc1 Lpoll_811014_ok
  s_cbranch_vccnz Lpoll_811014
Lpoll_811014_ok:
  v_mfma_f32_16x16x32_bf16 v[16:19], a[224:227], v[208:211], v[16:19]
  v_mfma_f32_16x16x32_bf16 v[32:35], a[228:231], v[208:211], v[32:35]
  v_mfma_f32_16x16x32_bf16 v[48:51], a[232:235], v[208:211], v[48:51]
  v_mfma_f32_16x16x32_bf16 v[64:67], a[236:239], v[208:211], v[64:67]
  s_add_u32 s4, s52, 2871296
  buffer_load_dwordx4 a[116:119], v171, s[20:23], s4 offen offset:0 sc1
  s_waitcnt vmcnt(12)
  v_mfma_f32_16x16x32_bf16 v[4:7], a[220:223], v[212:215], v[4:7]
  v_mfma_f32_16x16x32_bf16 v[20:23], a[224:227], v[212:215], v[20:23]
  v_mfma_f32_16x16x32_bf16 v[36:39], a[228:231], v[212:215], v[36:39]
  v_mfma_f32_16x16x32_bf16 v[52:55], a[232:235], v[212:215], v[52:55]
  v_mfma_f32_16x16x32_bf16 v[68:71], a[236:239], v[212:215], v[68:71]
  s_add_u32 s95, s95, 16384
  buffer_load_dwordx4 v[144:147], v141, s[32:35], s95 offen offset:0 sc1
  s_waitcnt vmcnt(12)
  v_mfma_f32_16x16x32_bf16 v[8:11], a[220:223], v[216:219], v[8:11]
  v_mfma_f32_16x16x32_bf16 v[24:27], a[224:227], v[216:219], v[24:27]
  v_mfma_f32_16x16x32_bf16 v[40:43], a[228:231], v[216:219], v[40:43]
  v_mfma_f32_16x16x32_bf16 v[56:59], a[232:235], v[216:219], v[56:59]
  v_mfma_f32_16x16x32_bf16 v[72:75], a[236:239], v[216:219], v[72:75]
  buffer_load_dwordx4 v[148:151], v141, s[32:35], s95 offen offset:256 sc1
  s_waitcnt vmcnt(12)
  v_mfma_f32_16x16x32_bf16 v[12:15], a[220:223], v[220:223], v[12:15]
  v_mfma_f32_16x16x32_bf16 v[28:31], a[224:227], v[220:223], v[28:31]
  v_mfma_f32_16x16x32_bf16 v[44:47], a[228:231], v[220:223], v[44:47]
  v_mfma_f32_16x16x32_bf16 v[60:63], a[232:235], v[220:223], v[60:63]
  v_mfma_f32_16x16x32_bf16 v[76:79], a[236:239], v[220:223], v[76:79]
  buffer_load_dwordx4 v[152:155], v142, s[32:35], s95 offen offset:0 sc1
  buffer_load_dwordx4 v[156:159], v142, s[32:35], s95 offen offset:256 sc1
  s_waitcnt vmcnt(12)
  v_mfma_f32_16x16x32_bf16 v[0:3], a[240:243], v[224:227], v[0:3]
  v_mfma_f32_16x16x32_bf16 v[16:19], a[244:247], v[224:227], v[16:19]
  v_mfma_f32_16x16x32_bf16 v[32:35], a[248:251], v[224:227], v[32:35]
  v_mfma_f32_16x16x32_bf16 v[48:51], a[252:255], v[224:227], v[48:51]
  v_mfma_f32_16x16x32_bf16 v[64:67], v[240:243], v[224:227], v[64:67]
  s_lshl_b32 s5, s86, 5
  s_add_u32 s5, s5, s3
  s_lshl_b32 s5, s5, 11
  s_add_u32 s5, s5, 19922944
  s_lshl_b32 s6, s86, 3
  s_add_u32 s6, s6, s3
  s_lshl_b32 s6, s6, 11
  s_add_u32 s6, s6, 22020096
  s_add_u32 s7, s5, 0
  buffer_load_dwordx4 a[120:123], v141, s[20:23], s7 offen offset:0 sc1
  s_waitcnt vmcnt(12)
  v_mfma_f32_16x16x32_bf16 v[4:7], a[240:243], v[228:231], v[4:7]
  v_mfma_f32_16x16x32_bf16 v[20:23], a[244:247], v[228:231], v[20:23]
  v_mfma_f32_16x16x32_bf16 v[36:39], a[248:251], v[228:231], v[36:39]
  v_mfma_f32_16x16x32_bf16 v[52:55], a[252:255], v[228:231], v[52:55]
  v_mfma_f32_16x16x32_bf16 v[68:71], v[240:243], v[228:231], v[68:71]
  s_waitcnt vmcnt(11)
  v_mfma_f32_16x16x32_bf16 v[8:11], a[240:243], v[232:235], v[8:11]
  v_mfma_f32_16x16x32_bf16 v[24:27], a[244:247], v[232:235], v[24:27]
  v_mfma_f32_16x16x32_bf16 v[40:43], a[248:251], v[232:235], v[40:43]
  v_mfma_f32_16x16x32_bf16 v[56:59], a[252:255], v[232:235], v[56:59]
  v_mfma_f32_16x16x32_bf16 v[72:75], v[240:243], v[232:235], v[72:75]
  s_add_u32 s7, s5, 8192
  buffer_load_dwordx4 a[136:139], v141, s[20:23], s7 offen offset:0 sc1
  s_waitcnt vmcnt(11)
  v_mfma_f32_16x16x32_bf16 v[12:15], a[240:243], v[236:239], v[12:15]
  v_mfma_f32_16x16x32_bf16 v[28:31], a[244:247], v[236:239], v[28:31]
  v_mfma_f32_16x16x32_bf16 v[44:47], a[248:251], v[236:239], v[44:47]
  v_mfma_f32_16x16x32_bf16 v[60:63], a[252:255], v[236:239], v[60:63]
  v_mfma_f32_16x16x32_bf16 v[76:79], v[240:243], v[236:239], v[76:79]
  s_add_u32 s7, s5, 16384
  buffer_load_dwordx4 a[152:155], v141, s[20:23], s7 offen offset:0 sc1
  s_add_u32 s7, s5, 24576
  buffer_load_dwordx4 a[168:171], v141, s[20:23], s7 offen offset:0 sc1
  buffer_load_dwordx2 a[184:185], v120, s[20:23], s6 offen offset:0 sc1
  buffer_load_dwordx2 a[186:187], v120, s[20:23], s6 offen offset:256 sc1
  s_add_u32 s7, s5, 0
  buffer_load_dwordx4 a[124:127], v141, s[20:23], s7 offen offset:256 sc1
  s_add_u32 s7, s5, 8192
  buffer_load_dwordx4 a[140:143], v141, s[20:23], s7 offen offset:256 sc1
  s_add_u32 s7, s5, 16384
  buffer_load_dwordx4 a[156:159], v141, s[20:23], s7 offen offset:256 sc1
  s_waitcnt vmcnt(12) lgkmcnt(0)
  v_mfma_f32_16x16x32_bf16 v[0:3], a[0:3], v[144:147], v[0:3]
  v_mfma_f32_16x16x32_bf16 v[16:19], a[4:7], v[144:147], v[16:19]
  v_mfma_f32_16x16x32_bf16 v[32:35], a[8:11], v[144:147], v[32:35]
  v_mfma_f32_16x16x32_bf16 v[48:51], a[12:15], v[144:147], v[48:51]
  v_mfma_f32_16x16x32_bf16 v[64:67], a[16:19], v[144:147], v[64:67]
  s_add_u32 s7, s5, 24576
  buffer_load_dwordx4 a[172:175], v141, s[20:23], s7 offen offset:256 sc1
  s_waitcnt vmcnt(12)
  v_mfma_f32_16x16x32_bf16 v[4:7], a[0:3], v[148:151], v[4:7]
  v_mfma_f32_16x16x32_bf16 v[20:23], a[4:7], v[148:151], v[20:23]
  v_mfma_f32_16x16x32_bf16 v[36:39], a[8:11], v[148:151], v[36:39]
  v_mfma_f32_16x16x32_bf16 v[52:55], a[12:15], v[148:151], v[52:55]
  v_mfma_f32_16x16x32_bf16 v[68:71], a[16:19], v[148:151], v[68:71]
  buffer_load_dwordx2 a[188:189], v120, s[20:23], s6 offen offset:128 sc1
  buffer_load_dwordx2 a[190:191], v120, s[20:23], s6 offen offset:384 sc1
  s_waitcnt vmcnt(13)
  v_mfma_f32_16x16x32_bf16 v[8:11], a[0:3], v[152:155], v[8:11]
  v_mfma_f32_16x16x32_bf16 v[24:27], a[4:7], v[152:155], v[24:27]
  v_mfma_f32_16x16x32_bf16 v[40:43], a[8:11], v[152:155], v[40:43]
  v_mfma_f32_16x16x32_bf16 v[56:59], a[12:15], v[152:155], v[56:59]
  v_mfma_f32_16x16x32_bf16 v[72:75], a[16:19], v[152:155], v[72:75]
  s_waitcnt vmcnt(12)
  v_mfma_f32_16x16x32_bf16 v[12:15], a[0:3], v[156:159], v[12:15]
  v_mfma_f32_16x16x32_bf16 v[28:31], a[4:7], v[156:159], v[28:31]
  v_mfma_f32_16x16x32_bf16 v[44:47], a[8:11], v[156:159], v[44:47]
  v_mfma_f32_16x16x32_bf16 v[60:63], a[12:15], v[156:159], v[60:63]
  v_mfma_f32_16x16x32_bf16 v[76:79], a[16:19], v[156:159], v[76:79]
  s_waitcnt vmcnt(11)
  v_mfma_f32_16x16x32_bf16 v[0:3], a[20:23], a[120:123], v[0:3]
  v_mfma_f32_16x16x32_bf16 v[16:19], a[24:27], a[120:123], v[16:19]
  s_add_u32 s7, s5, 0
  buffer_load_dwordx4 a[128:131], v143, s[20:23], s7 offen offset:0 sc1
  v_mfma_f32_16x16x32_bf16 v[32:35], a[28:31], a[120:123], v[32:35]
  v_mfma_f32_16x16x32_bf16 v[48:51], a[32:35], a[120:123], v[48:51]
  v_mfma_f32_16x16x32_bf16 v[64:67], a[36:39], a[120:123], v[64:67]
  s_waitcnt vmcnt(11)
  v_mfma_f32_16x16x32_bf16 v[0:3], a[40:43], a[136:139], v[0:3]
  v_mfma_f32_16x16x32_bf16 v[16:19], a[44:47], a[136:139], v[16:19]
  s_add_u32 s7, s5, 8192
  buffer_load_dwordx4 a[144:147], v143, s[20:23], s7 offen offset:0 sc1
  v_mfma_f32_16x16x32_bf16 v[32:35], a[48:51], a[136:139], v[32:35]
  v_mfma_f32_16x16x32_bf16 v[48:51], a[52:55], a[136:139], v[48:51]
  v_mfma_f32_16x16x32_bf16 v[64:67], a[56:59], a[136:139], v[64:67]
  s_waitcnt vmcnt(11)
  v_mfma_f32_16x16x32_bf16 v[0:3], a[60:63], a[152:155], v[0:3]
  v_mfma_f32_16x16x32_bf16 v[16:19], a[64:67], a[152:155], v[16:19]
  v_mfma_f32_16x16x32_bf16 v[32:35], a[68:71], a[152:155], v[32:35]
  s_add_u32 s7, s5, 16384
  buffer_load_dwordx4 a[160:163], v143, s[20:23], s7 offen offset:0 sc1
  v_mfma_f32_16x16x32_bf16 v[48:51], a[72:75], a[152:155], v[48:51]
  v_mfma_f32_16x16x32_bf16 v[64:67], a[76:79], a[152:155], v[64:67]
  s_waitcnt vmcnt(11)
  v_mfma_f32_16x16x32_bf16 v[0:3], a[80:83], a[168:171], v[0:3]
  v_mfma_f32_16x16x32_bf16 v[16:19], a[84:87], a[168:171], v[16:19]
  v_mfma_f32_16x16x32_bf16 v[32:35], a[88:91], a[168:171], v[32:35]
  s_add_u32 s7, s5, 24576
  buffer_load_dwordx4 a[176:179], v143, s[20:23], s7 offen offset:0 sc1
  v_mfma_f32_16x16x32_bf16 v[48:51], a[92:95], a[168:171], v[48:51]
  v_mfma_f32_16x16x32_bf16 v[64:67], a[96:99], a[168:171], v[64:67]
  buffer_load_dwordx2 a[192:193], v121, s[20:23], s6 offen offset:0 sc1
  buffer_load_dwordx2 a[194:195], v121, s[20:23], s6 offen offset:256 sc1
  s_waitcnt vmcnt(12)
  v_mfma_f32_16x16x32_bf16 v[0:3], a[100:103], a[184:187], v[0:3]
  s_barrier
  v_mfma_f32_16x16x32_bf16 v[16:19], a[104:107], a[184:187], v[16:19]
  v_mfma_f32_16x16x32_bf16 v[32:35], a[108:111], a[184:187], v[32:35]
  v_mfma_f32_16x16x32_bf16 v[48:51], a[112:115], a[184:187], v[48:51]
  v_mfma_f32_16x16x32_bf16 v[64:67], a[116:119], a[184:187], v[64:67]
  s_waitcnt vmcnt(11)
  v_mfma_f32_16x16x32_bf16 v[4:7], a[20:23], a[124:127], v[4:7]
  v_mfma_f32_16x16x32_bf16 v[20:23], a[24:27], a[124:127], v[20:23]
  v_mfma_f32_16x16x32_bf16 v[36:39], a[28:31], a[124:127], v[36:39]
  v_mfma_f32_16x16x32_bf16 v[52:55], a[32:35], a[124:127], v[52:55]
  ds_write_b128 v122, v[0:3] offset:0
  v_mfma_f32_16x16x32_bf16 v[68:71], a[36:39], a[124:127], v[68:71]
  s_add_u32 s7, s5, 0
  buffer_load_dwordx4 a[132:135], v143, s[20:23], s7 offen offset:256 sc1
  s_waitcnt vmcnt(11)
  v_mfma_f32_16x16x32_bf16 v[4:7], a[40:43], a[140:143], v[4:7]
  v_mfma_f32_16x16x32_bf16 v[20:23], a[44:47], a[140:143], v[20:23]
  v_mfma_f32_16x16x32_bf16 v[36:39], a[48:51], a[140:143], v[36:39]
  ds_write_b128 v122, v[16:19] offset:64
  v_mfma_f32_16x16x32_bf16 v[52:55], a[52:55], a[140:143], v[52:55]
  v_mfma_f32_16x16x32_bf16 v[68:71], a[56:59], a[140:143], v[68:71]
  s_waitcnt vmcnt(10)
  v_mfma_f32_16x16x32_bf16 v[4:7], a[60:63], a[156:159], v[4:7]
  s_add_u32 s7, s5, 8192
  buffer_load_dwordx4 a[148:151], v143, s[20:23], s7 offen offset:256 sc1
  v_mfma_f32_16x16x32_bf16 v[20:23], a[64:67], a[156:159], v[20:23]
  ds_write_b128 v122, v[32:35] offset:128
  v_mfma_f32_16x16x32_bf16 v[36:39], a[68:71], a[156:159], v[36:39]
  v_mfma_f32_16x16x32_bf16 v[52:55], a[72:75], a[156:159], v[52:55]
  v_mfma_f32_16x16x32_bf16 v[68:71], a[76:79], a[156:159], v[68:71]
  s_add_u32 s7, s5, 16384
  buffer_load_dwordx4 a[164:167], v143, s[20:23], s7 offen offset:256 sc1
  s_waitcnt vmcnt(11)
  v_mfma_f32_16x16x32_bf16 v[4:7], a[80:83], a[172:175], v[4:7]
  ds_write_b128 v122, v[48:51] offset:192
  v_mfma_f32_16x16x32_bf16 v[20:23], a[84:87], a[172:175], v[20:23]
  v_mfma_f32_16x16x32_bf16 v[36:39], a[88:91], a[172:175], v[36:39]
  v_mfma_f32_16x16x32_bf16 v[52:55], a[92:95], a[172:175], v[52:55]
  v_mfma_f32_16x16x32_bf16 v[68:71], a[96:99], a[172:175], v[68:71]
  ds_write_b128 v122, v[64:67] offset:256
  s_add_u32 s7, s5, 24576
  buffer_load_dwordx4 a[180:183], v143, s[20:23], s7 offen offset:256 sc1
  buffer_load_dwordx2 a[196:197], v121, s[20:23], s6 offen offset:128 sc1
  buffer_load_dwordx2 a[198:199], v121, s[20:23], s6 offen offset:384 sc1
  s_waitcnt vmcnt(12)
  v_mfma_f32_16x16x32_bf16 v[4:7], a[100:103], a[188:191], v[4:7]
  v_mfma_f32_16x16x32_bf16 v[20:23], a[104:107], a[188:191], v[20:23]
  v_mfma_f32_16x16x32_bf16 v[36:39], a[108:111], a[188:191], v[36:39]
  v_mfma_f32_16x16x32_bf16 v[52:55], a[112:115], a[188:191], v[52:55]
  v_mfma_f32_16x16x32_bf16 v[68:71], a[116:119], a[188:191], v[68:71]
  s_waitcnt vmcnt(11)
  v_mfma_f32_16x16x32_bf16 v[8:11], a[20:23], a[128:131], v[8:11]
  v_mfma_f32_16x16x32_bf16 v[24:27], a[24:27], a[128:131], v[24:27]
  v_mfma_f32_16x16x32_bf16 v[40:43], a[28:31], a[128:131], v[40:43]
  v_mfma_f32_16x16x32_bf16 v[56:59], a[32:35], a[128:131], v[56:59]
  ds_write_b128 v122, v[4:7] offset:5376
  v_mfma_f32_16x16x32_bf16 v[72:75], a[36:39], a[128:131], v[72:75]
  s_waitcnt vmcnt(10)
  v_mfma_f32_16x16x32_bf16 v[8:11], a[40:43], a[144:147], v[8:11]
  v_mfma_f32_16x16x32_bf16 v[24:27], a[44:47], a[144:147], v[24:27]
  v_mfma_f32_16x16x32_bf16 v[40:43], a[48:51], a[144:147], v[40:43]
  ds_write_b128 v122, v[20:23] offset:5440
  v_mfma_f32_16x16x32_bf16 v[56:59], a[52:55], a[144:147], v[56:59]
  v_mfma_f32_16x16x32_bf16 v[72:75], a[56:59], a[144:147], v[72:75]
  s_waitcnt vmcnt(9)
  v_mfma_f32_16x16x32_bf16 v[8:11], a[60:63], a[160:163], v[8:11]
  v_mfma_f32_16x16x32_bf16 v[24:27], a[64:67], a[160:163], v[24:27]
  ds_write_b128 v122, v[36:39] offset:5504
  v_mfma_f32_16x16x32_bf16 v[40:43], a[68:71], a[160:163], v[40:43]
  v_mfma_f32_16x16x32_bf16 v[56:59], a[72:75], a[160:163], v[56:59]
  v_mfma_f32_16x16x32_bf16 v[72:75], a[76:79], a[160:163], v[72:75]
  s_waitcnt vmcnt(8)
  v_mfma_f32_16x16x32_bf16 v[8:11], a[80:83], a[176:179], v[8:11]
  ds_write_b128 v122, v[52:55] offset:5568
  v_mfma_f32_16x16x32_bf16 v[24:27], a[84:87], a[176:179], v[24:27]
  v_mfma_f32_16x16x32_bf16 v[40:43], a[88:91], a[176:179], v[40:43]
  v_mfma_f32_16x16x32_bf16 v[56:59], a[92:95], a[176:179], v[56:59]
  v_mfma_f32_16x16x32_bf16 v[72:75], a[96:99], a[176:179], v[72:75]
  ds_write_b128 v122, v[68:71] offset:5632
  s_waitcnt vmcnt(6)
  v_mfma_f32_16x16x32_bf16 v[8:11], a[100:103], a[192:195], v[8:11]
  v_mfma_f32_16x16x32_bf16 v[24:27], a[104:107], a[192:195], v[24:27]
  v_mfma_f32_16x16x32_bf16 v[40:43], a[108:111], a[192:195], v[40:43]
  v_mfma_f32_16x16x32_bf16 v[56:59], a[112:115], a[192:195], v[56:59]
  v_mfma_f32_16x16x32_bf16 v[72:75], a[116:119], a[192:195], v[72:75]
  s_waitcnt vmcnt(5)
  v_mfma_f32_16x16x32_bf16 v[12:15], a[20:23], a[132:135], v[12:15]
  v_mfma_f32_16x16x32_bf16 v[28:31], a[24:27], a[132:135], v[28:31]
  v_mfma_f32_16x16x32_bf16 v[44:47], a[28:31], a[132:135], v[44:47]
  v_mfma_f32_16x16x32_bf16 v[60:63], a[32:35], a[132:135], v[60:63]
  ds_write_b128 v122, v[8:11] offset:10752
  v_mfma_f32_16x16x32_bf16 v[76:79], a[36:39], a[132:135], v[76:79]
  s_waitcnt vmcnt(4)
  v_mfma_f32_16x16x32_bf16 v[12:15], a[40:43], a[148:151], v[12:15]
  v_mfma_f32_16x16x32_bf16 v[28:31], a[44:47], a[148:151], v[28:31]
  v_mfma_f32_16x16x32_bf16 v[44:47], a[48:51], a[148:151], v[44:47]
  ds_write_b128 v122, v[24:27] offset:10816
  v_mfma_f32_16x16x32_bf16 v[60:63], a[52:55], a[148:151], v[60:63]
  v_mfma_f32_16x16x32_bf16 v[76:79], a[56:59], a[148:151], v[76:79]
  s_waitcnt vmcnt(3)
  v_mfma_f32_16x16x32_bf16 v[12:15], a[60:63], a[164:167], v[12:15]
  v_mfma_f32_16x16x32_bf16 v[28:31], a[64:67], a[164:167], v[28:31]
  ds_write_b128 v122, v[40:43] offset:10880
  v_mfma_f32_16x16x32_bf16 v[44:47], a[68:71], a[164:167], v[44:47]
  v_mfma_f32_16x16x32_bf16 v[60:63], a[72:75], a[164:167], v[60:63]
  v_mfma_f32_16x16x32_bf16 v[76:79], a[76:79], a[164:167], v[76:79]
  s_waitcnt vmcnt(2)
  v_mfma_f32_16x16x32_bf16 v[12:15], a[80:83], a[180:183], v[12:15]
  ds_write_b128 v122, v[56:59] offset:10944
  v_mfma_f32_16x16x32_bf16 v[28:31], a[84:87], a[180:183], v[28:31]
  v_mfma_f32_16x16x32_bf16 v[44:47], a[88:91], a[180:183], v[44:47]
  v_mfma_f32_16x16x32_bf16 v[60:63], a[92:95], a[180:183], v[60:63]
  v_mfma_f32_16x16x32_bf16 v[76:79], a[96:99], a[180:183], v[76:79]
  ds_write_b128 v122, v[72:75] offset:11008
  s_waitcnt vmcnt(0)
  v_mfma_f32_16x16x32_bf16 v[12:15], a[100:103], a[196:199], v[12:15]
  v_mfma_f32_16x16x32_bf16 v[28:31], a[104:107], a[196:199], v[28:31]
  v_mfma_f32_16x16x32_bf16 v[44:47], a[108:111], a[196:199], v[44:47]
  v_mfma_f32_16x16x32_bf16 v[60:63], a[112:115], a[196:199], v[60:63]
  v_mfma_f32_16x16x32_bf16 v[76:79], a[116:119], a[196:199], v[76:79]
  s_nop 3
  ds_write_b128 v122, v[12:15] offset:16128
  ds_write_b128 v122, v[28:31] offset:16192
  ds_write_b128 v122, v[44:47] offset:16256
  ds_write_b128 v122, v[60:63] offset:16320
  ds_write_b128 v122, v[76:79] offset:16384
  s_waitcnt lgkmcnt(0)
  s_barrier
  ds_read_b128 v[0:3], v115 offset:0
  ds_read_b128 v[4:7], v115 offset:21504
  ds_read_b128 v[8:11], v115 offset:43008
  ds_read_b128 v[12:15], v115 offset:64512
  ds_read_b128 v[16:19], v116 offset:0
  ds_read_b128 v[20:23], v116 offset:21504
  ds_read_b128 v[24:27], v116 offset:43008
  ds_read_b128 v[28:31], v116 offset:64512
  ds_read_b128 v[32:35], v117 offset:0
  ds_read_b128 v[36:39], v117 offset:21504
  ds_read_b128 v[40:43], v117 offset:43008
  ds_read_b128 v[44:47], v117 offset:64512
  ds_read_b128 v[48:51], v118 offset:0
  ds_read_b128 v[52:55], v118 offset:21504
  ds_read_b128 v[56:59], v118 offset:43008
  ds_read_b128 v[60:63], v118 offset:64512
  ds_read_b128 v[64:67], v119 offset:0
  ds_read_b128 v[68:71], v119 offset:21504
  ds_read_b128 v[72:75], v119 offset:43008
  ds_read_b128 v[76:79], v119 offset:64512
  s_waitcnt lgkmcnt(15)
  v_pk_add_f32 v[0:1], v[0:1], v[4:5]
  v_pk_add_f32 v[2:3], v[2:3], v[6:7]
  s_waitcnt lgkmcnt(15)
  v_pk_add_f32 v[8:9], v[8:9], v[12:13]
  v_pk_add_f32 v[10:11], v[10:11], v[14:15]
  v_pk_add_f32 v[0:1], v[0:1], v[80:81]
  v_pk_add_f32 v[2:3], v[2:3], v[82:83]
  v_pk_add_f32 v[0:1], v[0:1], v[8:9]
  v_pk_add_f32 v[2:3], v[2:3], v[10:11]
  v_cvt_pk_bf16_f32 v0, v0, v1
  v_cvt_pk_bf16_f32 v1, v2, v3
  buffer_store_dwordx2 v[0:1], v110, s[24:27], s96 offen
  s_waitcnt lgkmcnt(14)
  v_pk_add_f32 v[16:17], v[16:17], v[20:21]
  v_pk_add_f32 v[18:19], v[18:19], v[22:23]
  s_waitcnt lgkmcnt(12)
  v_pk_add_f32 v[24:25], v[24:25], v[28:29]
  v_pk_add_f32 v[26:27], v[26:27], v[30:31]
  v_pk_add_f32 v[16:17], v[16:17], v[84:85]
  v_pk_add_f32 v[18:19], v[18:19], v[86:87]
  v_pk_add_f32 v[16:17], v[16:17], v[24:25]
  v_pk_add_f32 v[18:19], v[18:19], v[26:27]
  v_cvt_pk_bf16_f32 v16, v16, v17
  v_cvt_pk_bf16_f32 v17, v18, v19
  buffer_store_dwordx2 v[16:17], v111, s[24:27], s96 offen
  s_waitcnt lgkmcnt(7)
  v_pk_add_f32 v[32:33], v[32:33], v[36:37]
  v_pk_add_f32 v[34:35], v[34:35], v[38:39]
  v_pk_add_f32 v[40:41], v[40:41], v[44:45]
  v_pk_add_f32 v[42:43], v[42:43], v[46:47]
  v_pk_add_f32 v[32:33], v[32:33], v[88:89]
  v_pk_add_f32 v[34:35], v[34:35], v[90:91]
  v_pk_add_f32 v[32:33], v[32:33], v[40:41]
  v_pk_add_f32 v[34:35], v[34:35], v[42:43]
  v_cvt_pk_bf16_f32 v32, v32, v33
  v_cvt_pk_bf16_f32 v33, v34, v35
  buffer_store_dwordx2 v[32:33], v112, s[24:27], s96 offen
  s_waitcnt lgkmcnt(0)
  v_pk_add_f32 v[48:49], v[48:49], v[52:53]
  v_pk_add_f32 v[50:51], v[50:51], v[54:55]
  v_pk_add_f32 v[56:57], v[56:57], v[60:61]
  v_pk_add_f32 v[58:59], v[58:59], v[62:63]
  v_pk_add_f32 v[48:49], v[48:49], v[92:93]
  v_pk_add_f32 v[50:51], v[50:51], v[94:95]
  v_pk_add_f32 v[48:49], v[48:49], v[56:57]
  v_pk_add_f32 v[50:51], v[50:51], v[58:59]
  v_cvt_pk_bf16_f32 v48, v48, v49
  v_cvt_pk_bf16_f32 v49, v50, v51
  buffer_store_dwordx2 v[48:49], v113, s[24:27], s96 offen
  v_pk_add_f32 v[64:65], v[64:65], v[68:69]
  v_pk_add_f32 v[66:67], v[66:67], v[70:71]
  v_pk_add_f32 v[72:73], v[72:73], v[76:77]
  v_pk_add_f32 v[74:75], v[74:75], v[78:79]
  v_pk_add_f32 v[64:65], v[64:65], v[96:97]
  v_pk_add_f32 v[66:67], v[66:67], v[98:99]
  v_pk_add_f32 v[64:65], v[64:65], v[72:73]
  v_pk_add_f32 v[66:67], v[66:67], v[74:75]
  v_cvt_pk_bf16_f32 v64, v64, v65
  v_cvt_pk_bf16_f32 v65, v66, v67
  buffer_store_dwordx2 v[64:65], v114, s[24:27], s96 offen
  s_waitcnt vmcnt(0)
L_end:
  s_endpgm
L_slow:
  s_waitcnt lgkmcnt(0)
  s_lshl_b32 s66, s85, 3
  s_lshl_b32 s67, s3, 1
  s_add_u32 s66, s66, s67
  v_mov_b32 v180, 0xf1800000
  s_cmp_lt_u32 s66, 8
  s_cbranch_scc1 Lsl_901
  ds_read_b128 v[144:147], v138 offset:0
  ds_read_b64 v[148:149], v139 offset:0
  s_waitcnt lgkmcnt(1)
  v_mfma_f32_32x32x16_bf16 v[64:79], v[144:147], v[124:127], v[48:63]
  s_waitcnt lgkmcnt(0)
  v_mfma_f32_32x32x8_bf16 v[64:79], v[148:149], v[128:129], v[64:79]
  s_nop 11
  v_max3_f32 v180, v64, v65, v180
  v_max3_f32 v180, v66, v67, v180
  v_max3_f32 v180, v68, v69, v180
  v_max3_f32 v180, v70, v71, v180
  v_max3_f32 v180, v72, v73, v180
  v_max3_f32 v180, v74, v75, v180
  v_max3_f32 v180, v76, v77, v180
  v_max3_f32 v180, v78, v79, v180
Lsl_901:
  s_cmp_lt_u32 s66, 7
  s_cbranch_scc1 Lsl_902
  ds_read_b128 v[150:153], v138 offset:512
  ds_read_b64 v[154:155], v139 offset:512
  s_waitcnt lgkmcnt(1)
  v_mfma_f32_32x32x16_bf16 v[64:79], v[150:153], v[124:127], 0
  s_waitcnt lgkmcnt(0)
  v_mfma_f32_32x32x8_bf16 v[64:79], v[154:155], v[128:129], v[64:79]
  s_nop 11
  v_max3_f32 v180, v64, v65, v180
  v_max3_f32 v180, v66, v67, v180
  v_max3_f32 v180, v68, v69, v180
  v_max3_f32 v180, v70, v71, v180
  v_max3_f32 v180, v72, v73, v180
  v_max3_f32 v180, v74, v75, v180
  v_max3_f32 v180, v76, v77, v180
  v_max3_f32 v180, v78, v79, v180
Lsl_902:
  s_cmp_lt_u32 s66, 6
  s_cbranch_scc1 Lsl_903
  ds_read_b128 v[156:159], v138 offset:1024
  ds_read_b64 v[160:161], v139 offset:1024
  s_waitcnt lgkmcnt(1)
  v_mfma_f32_32x32x16_bf16 v[64:79], v[156:159], v[124:127], 0
  s_waitcnt lgkmcnt(0)
  v_mfma_f32_32x32x8_bf16 v[64:79], v[160:161], v[128:129], v[64:79]
  s_nop 11
  v_max3_f32 v180, v64, v65, v180
  v_max3_f32 v180, v66, v67, v180
  v_max3_f32 v180, v68, v69, v180
  v_max3_f32 v180, v70, v71, v180
  v_max3_f32 v180, v72, v73, v180
  v_max3_f32 v180, v74, v75, v180
  v_max3_f32 v180, v76, v77, v180
  v_max3_f32 v180, v78, v79, v180
Lsl_903:
  s_cmp_lt_u32 s66, 5
  s_cbranch_scc1 Lsl_904
  ds_read_b128 v[144:147], v138 offset:1536
  ds_read_b64 v[148:149], v139 offset:1536
  s_waitcnt lgkmcnt(1)
  v_mfma_f32_32x32x16_bf16 v[64:79], v[144:147], v[124:127], 0
  s_waitcnt lgkmcnt(0)
  v_mfma_f32_32x32x8_bf16 v[64:79], v[148:149], v[128:129], v[64:79]
  s_nop 11
  v_max3_f32 v180, v64, v65, v180
  v_max3_f32 v180, v66, v67, v180
  v_max3_f32 v180, v68, v69, v180
  v_max3_f32 v180, v70, v71, v180
  v_max3_f32 v180, v72, v73, v180
  v_max3_f32 v180, v74, v75, v180
  v_max3_f32 v180, v76, v77, v180
  v_max3_f32 v180, v78, v79, v180
Lsl_904:
  s_cmp_lt_u32 s66, 4
  s_cbranch_scc1 Lsl_905
  ds_read_b128 v[150:153], v138 offset:2048
  ds_read_b64 v[154:155], v139 offset:2048
  s_waitcnt lgkmcnt(1)
  v_mfma_f32_32x32x16_bf16 v[64:79], v[150:153], v[124:127], 0
  s_waitcnt lgkmcnt(0)
  v_mfma_f32_32x32x8_bf16 v[64:79], v[154:155], v[128:129], v[64:79]
  s_nop 11
  v_max3_f32 v180, v64, v65, v180
  v_max3_f32 v180, v66, v67, v180
  v_max3_f32 v180, v68, v69, v180
  v_max3_f32 v180, v70, v71, v180
  v_max3_f32 v180, v72, v73, v180
  v_max3_f32 v180, v74, v75, v180
  v_max3_f32 v180, v76, v77, v180
  v_max3_f32 v180, v78, v79, v180
Lsl_905:
  s_cmp_lt_u32 s66, 3
  s_cbranch_scc1 Lsl_906
  ds_read_b128 v[156:159], v138 offset:2560
  ds_read_b64 v[160:161], v139 offset:2560
  s_waitcnt lgkmcnt(1)
  v_mfma_f32_32x32x16_bf16 v[64:79], v[156:159], v[124:127], 0
  s_waitcnt lgkmcnt(0)
  v_mfma_f32_32x32x8_bf16 v[64:79], v[160:161], v[128:129], v[64:79]
  s_nop 11
  v_max3_f32 v180, v64, v65, v180
  v_max3_f32 v180, v66, v67, v180
  v_max3_f32 v180, v68, v69, v180
  v_max3_f32 v180, v70, v71, v180
  v_max3_f32 v180, v72, v73, v180
  v_max3_f32 v180, v74, v75, v180
  v_max3_f32 v180, v76, v77, v180
  v_max3_f32 v180, v78, v79, v180
Lsl_906:
  s_cmp_lt_u32 s66, 2
  s_cbranch_scc1 Lsl_907
  ds_read_b128 v[144:147], v138 offset:3072
  ds_read_b64 v[148:149], v139 offset:3072
  s_waitcnt lgkmcnt(1)
  v_mfma_f32_32x32x16_bf16 v[64:79], v[144:147], v[124:127], 0
  s_waitcnt lgkmcnt(0)
  v_mfma_f32_32x32x8_bf16 v[64:79], v[148:149], v[128:129], v[64:79]
  s_nop 11
  v_max3_f32 v180, v64, v65, v180
  v_max3_f32 v180, v66, v67, v180
  v_max3_f32 v180, v68, v69, v180
  v_max3_f32 v180, v70, v71, v180
  v_max3_f32 v180, v72, v73, v180
  v_max3_f32 v180, v74, v75, v180
  v_max3_f32 v180, v76, v77, v180
  v_max3_f32 v180, v78, v79, v180
Lsl_907:
  s_cmp_lt_u32 s66, 1
  s_cbranch_scc1 Lsl_908
  ds_read_b128 v[150:153], v138 offset:3584
  ds_read_b64 v[154:155], v139 offset:3584
  s_waitcnt lgkmcnt(1)
  v_mfma_f32_32x32x16_bf16 v[64:79], v[150:153], v[124:127], 0
  s_waitcnt lgkmcnt(0)
  v_mfma_f32_32x32x8_bf16 v[64:79], v[154:155], v[128:129], v[64:79]
  s_nop 11
  v_max3_f32 v180, v64, v65, v180
  v_max3_f32 v180, v66, v67, v180
  v_max3_f32 v180, v68, v69, v180
  v_max3_f32 v180, v70, v71, v180
  v_max3_f32 v180, v72, v73, v180
  v_max3_f32 v180, v74, v75, v180
  v_max3_f32 v180, v76, v77, v180
  v_max3_f32 v180, v78, v79, v180
Lsl_908:
  s_cmp_lt_u32 s66, 0
  s_cbranch_scc1 Lsl_909
  ds_read_b128 v[156:159], v138 offset:4096
  ds_read_b64 v[160:161], v139 offset:4096
  s_waitcnt lgkmcnt(1)
  v_mfma_f32_32x32x16_bf16 v[64:79], v[156:159], v[124:127], v[32:47]
  s_waitcnt lgkmcnt(0)
  v_mfma_f32_32x32x8_bf16 v[64:79], v[160:161], v[128:129], v[64:79]
  s_nop 11
  v_max3_f32 v180, v64, v65, v180
  v_max3_f32 v180, v66, v67, v180
  v_max3_f32 v180, v68, v69, v180
  v_max3_f32 v180, v70, v71, v180
  v_max3_f32 v180, v72, v73, v180
  v_max3_f32 v180, v74, v75, v180
  v_max3_f32 v180, v76, v77, v180
  v_max3_f32 v180, v78, v79, v180
Lsl_909:
  v_mov_b32 v181, v180
  s_nop 1
  v_permlane32_swap_b32 v180, v181
  v_max_f32 v180, v180, v181
  v_sub_f32 v180, 0, v180
  v_cvt_pk_bf16_f32 v181, v180, v180
  v_and_b32 v182, 0xffff0000, v181
  v_sub_f32_e64 v180, v180, v182
  v_cvt_pk_bf16_f32 v181, v182, v180
  s_mov_b32 exec_lo, 0
  v_mov_b32 v128, v181
  s_mov_b32 exec_lo, -1
  v_mov_b32 v180, 0xf1800000
  s_cmp_lt_u32 s66, 7
  s_cbranch_scc1 Lsl_910
  ds_read_b128 v[150:153], v138 offset:512
  ds_read_b64 v[154:155], v139 offset:512
  s_waitcnt lgkmcnt(1)
  v_mfma_f32_32x32x16_bf16 v[64:79], v[150:153], v[134:137], v[48:63]
  s_waitcnt lgkmcnt(0)
  v_mfma_f32_32x32x8_bf16 v[64:79], v[154:155], v[130:131], v[64:79]
  s_nop 11
  v_max3_f32 v180, v64, v65, v180
  v_max3_f32 v180, v66, v67, v180
  v_max3_f32 v180, v68, v69, v180
  v_max3_f32 v180, v70, v71, v180
  v_max3_f32 v180, v72, v73, v180
  v_max3_f32 v180, v74, v75, v180
  v_max3_f32 v180, v76, v77, v180
  v_max3_f32 v180, v78, v79, v180
Lsl_910:
  s_cmp_lt_u32 s66, 6
  s_cbranch_scc1 Lsl_911
  ds_read_b128 v[156:159], v138 offset:1024
  ds_read_b64 v[160:161], v139 offset:1024
  s_waitcnt lgkmcnt(1)
  v_mfma_f32_32x32x16_bf16 v[64:79], v[156:159], v[134:137], 0
  s_waitcnt lgkmcnt(0)
  v_mfma_f32_32x32x8_bf16 v[64:79], v[160:161], v[130:131], v[64:79]
  s_nop 11
  v_max3_f32 v180, v64, v65, v180
  v_max3_f32 v180, v66, v67, v180
  v_max3_f32 v180, v68, v69, v180
  v_max3_f32 v180, v70, v71, v180
  v_max3_f32 v180, v72, v73, v180
  v_max3_f32 v180, v74, v75, v180
  v_max3_f32 v180, v76, v77, v180
  v_max3_f32 v180, v78, v79, v180
Lsl_911:
  s_cmp_lt_u32 s66, 5
  s_cbranch_scc1 Lsl_912
  ds_read_b128 v[144:147], v138 offset:1536
  ds_read_b64 v[148:149], v139 offset:1536
  s_waitcnt lgkmcnt(1)
  v_mfma_f32_32x32x16_bf16 v[64:79], v[144:147], v[134:137], 0
  s_waitcnt lgkmcnt(0)
  v_mfma_f32_32x32x8_bf16 v[64:79], v[148:149], v[130:131], v[64:79]
  s_nop 11
  v_max3_f32 v180, v64, v65, v180
  v_max3_f32 v180, v66, v67, v180
  v_max3_f32 v180, v68, v69, v180
  v_max3_f32 v180, v70, v71, v180
  v_max3_f32 v180, v72, v73, v180
  v_max3_f32 v180, v74, v75, v180
  v_max3_f32 v180, v76, v77, v180
  v_max3_f32 v180, v78, v79, v180
Lsl_912:
  s_cmp_lt_u32 s66, 4
  s_cbranch_scc1 Lsl_913
  ds_read_b128 v[150:153], v138 offset:2048
  ds_read_b64 v[154:155], v139 offset:2048
  s_waitcnt lgkmcnt(1)
  v_mfma_f32_32x32x16_bf16 v[64:79], v[150:153], v[134:137], 0
  s_waitcnt lgkmcnt(0)
  v_mfma_f32_32x32x8_bf16 v[64:79], v[154:155], v[130:131], v[64:79]
  s_nop 11
  v_max3_f32 v180, v64, v65, v180
  v_max3_f32 v180, v66, v67, v180
  v_max3_f32 v180, v68, v69, v180
  v_max3_f32 v180, v70, v71, v180
  v_max3_f32 v180, v72, v73, v180
  v_max3_f32 v180, v74, v75, v180
  v_max3_f32 v180, v76, v77, v180
  v_max3_f32 v180, v78, v79, v180
Lsl_913:
  s_cmp_lt_u32 s66, 3
  s_cbranch_scc1 Lsl_914
  ds_read_b128 v[156:159], v138 offset:2560
  ds_read_b64 v[160:161], v139 offset:2560
  s_waitcnt lgkmcnt(1)
  v_mfma_f32_32x32x16_bf16 v[64:79], v[156:159], v[134:137], 0
  s_waitcnt lgkmcnt(0)
  v_mfma_f32_32x32x8_bf16 v[64:79], v[160:161], v[130:131], v[64:79]
  s_nop 11
  v_max3_f32 v180, v64, v65, v180
  v_max3_f32 v180, v66, v67, v180
  v_max3_f32 v180, v68, v69, v180
  v_max3_f32 v180, v70, v71, v180
  v_max3_f32 v180, v72, v73, v180
  v_max3_f32 v180, v74, v75, v180
  v_max3_f32 v180, v76, v77, v180
  v_max3_f32 v180, v78, v79, v180
Lsl_914:
  s_cmp_lt_u32 s66, 2
  s_cbranch_scc1 Lsl_915
  ds_read_b128 v[144:147], v138 offset:3072
  ds_read_b64 v[148:149], v139 offset:3072
  s_waitcnt lgkmcnt(1)
  v_mfma_f32_32x32x16_bf16 v[64:79], v[144:147], v[134:137], 0
  s_waitcnt lgkmcnt(0)
  v_mfma_f32_32x32x8_bf16 v[64:79], v[148:149], v[130:131], v[64:79]
  s_nop 11
  v_max3_f32 v180, v64, v65, v180
  v_max3_f32 v180, v66, v67, v180
  v_max3_f32 v180, v68, v69, v180
  v_max3_f32 v180, v70, v71, v180
  v_max3_f32 v180, v72, v73, v180
  v_max3_f32 v180, v74, v75, v180
  v_max3_f32 v180, v76, v77, v180
  v_max3_f32 v180, v78, v79, v180
Lsl_915:
  s_cmp_lt_u32 s66, 1
  s_cbranch_scc1 Lsl_916
  ds_read_b128 v[150:153], v138 offset:3584
  ds_read_b64 v[154:155], v139 offset:3584
  s_waitcnt lgkmcnt(1)
  v_mfma_f32_32x32x16_bf16 v[64:79], v[150:153], v[134:137], 0
  s_waitcnt lgkmcnt(0)
  v_mfma_f32_32x32x8_bf16 v[64:79], v[154:155], v[130:131], v[64:79]
  s_nop 11
  v_max3_f32 v180, v64, v65, v180
  v_max3_f32 v180, v66, v67, v180
  v_max3_f32 v180, v68, v69, v180
  v_max3_f32 v180, v70, v71, v180
  v_max3_f32 v180, v72, v73, v180
  v_max3_f32 v180, v74, v75, v180
  v_max3_f32 v180, v76, v77, v180
  v_max3_f32 v180, v78, v79, v180
Lsl_916:
  s_cmp_lt_u32 s66, 0
  s_cbranch_scc1 Lsl_917
  ds_read_b128 v[156:159], v138 offset:4096
  ds_read_b64 v[160:161], v139 offset:4096
  s_waitcnt lgkmcnt(1)
  v_mfma_f32_32x32x16_bf16 v[64:79], v[156:159], v[134:137], 0
  s_waitcnt lgkmcnt(0)
  v_mfma_f32_32x32x8_bf16 v[64:79], v[160:161], v[130:131], v[64:79]
  s_nop 11
  v_max3_f32 v180, v64, v65, v180
  v_max3_f32 v180, v66, v67, v180
  v_max3_f32 v180, v68, v69, v180
  v_max3_f32 v180, v70, v71, v180
  v_max3_f32 v180, v72, v73, v180
  v_max3_f32 v180, v74, v75, v180
  v_max3_f32 v180, v76, v77, v180
  v_max3_f32 v180, v78, v79, v180
Lsl_917:
  s_cmp_lt_u32 s66, 0
  s_cbranch_scc1 Lsl_918
  ds_read_b128 v[144:147], v138 offset:4608
  ds_read_b64 v[148:149], v139 offset:4608
  s_waitcnt lgkmcnt(1)
  v_mfma_f32_32x32x16_bf16 v[64:79], v[144:147], v[134:137], v[32:47]
  s_waitcnt lgkmcnt(0)
  v_mfma_f32_32x32x8_bf16 v[64:79], v[148:149], v[130:131], v[64:79]
  s_nop 11
  v_max3_f32 v180, v64, v65, v180
  v_max3_f32 v180, v66, v67, v180
  v_max3_f32 v180, v68, v69, v180
  v_max3_f32 v180, v70, v71, v180
  v_max3_f32 v180, v72, v73, v180
  v_max3_f32 v180, v74, v75, v180
  v_max3_f32 v180, v76, v77, v180
  v_max3_f32 v180, v78, v79, v180
Lsl_918:
  v_mov_b32 v181, v180
  s_nop 1
  v_permlane32_swap_b32 v180, v181
  v_max_f32 v180, v180, v181
  v_sub_f32_e64 v180, 0, v180
  v_cvt_pk_bf16_f32 v181, v180, v180
  v_and_b32 v182, 0xffff0000, v181
  v_sub_f32 v180, v180, v182
  v_cvt_pk_bf16_f32 v181, v182, v180
  s_mov_b32 exec_lo, 0
  v_mov_b32 v130, v181
  s_mov_b32 exec_lo, -1
  ds_read_b128 v[144:147], v138 offset:0
  ds_read_b64 v[148:149], v139 offset:0
  ds_read_b128 v[150:153], v138 offset:512
  ds_read_b64 v[154:155], v139 offset:512
  ds_read_b64_tr_b16 v[112:113], v140 offset:0
  ds_read_b64_tr_b16 v[114:115], v140 offset:128
  ds_read_b64_tr_b16 v[116:117], v140 offset:256
  ds_read_b64_tr_b16 v[118:119], v140 offset:384
  ds_read_b64_tr_b16 v[172:173], v140 offset:512
  ds_read_b64_tr_b16 v[174:175], v140 offset:640
  ds_read_b64_tr_b16 v[176:177], v140 offset:768
  ds_read_b64_tr_b16 v[178:179], v140 offset:896
  ds_read_b128 v[156:159], v138 offset:1024
  ds_read_b64 v[160:161], v139 offset:1024
  s_waitcnt lgkmcnt(13)
  v_mfma_f32_32x32x16_bf16 v[64:79], v[144:147], v[124:127], v[48:63]
  s_waitcnt lgkmcnt(12)
  v_mfma_f32_32x32x8_bf16 v[64:79], v[148:149], v[128:129], v[64:79]
  s_nop 11
  v_exp_f32 v64, v64
  s_waitcnt lgkmcnt(11)
  v_mfma_f32_32x32x16_bf16 v[80:95], v[150:153], v[124:127], 0
  v_exp_f32 v65, v65
  v_exp_f32 v66, v66
  v_exp_f32 v67, v67
  v_cvt_pk_bf16_f32 v64, v64, v65
  v_exp_f32 v68, v68
  s_waitcnt lgkmcnt(10)
  v_mfma_f32_32x32x8_bf16 v[80:95], v[154:155], v[128:129], v[80:95]
  v_exp_f32_e64 v69, v69
  v_cvt_pk_bf16_f32 v65, v66, v67
  ds_read_b128 v[144:147], v138 offset:1536
  v_exp_f32 v70, v70
  v_exp_f32 v71, v71
  ds_read_b64 v[148:149], v139 offset:1536
  v_cvt_pk_bf16_f32 v66, v68, v69
  v_exp_f32 v72, v72
  v_exp_f32 v73, v73
  v_cvt_pk_bf16_f32 v67, v70, v71
  v_exp_f32 v74, v74
  v_exp_f32 v75, v75
  v_cvt_pk_bf16_f32 v68, v72, v73
  v_exp_f32 v76, v76
  v_exp_f32 v77, v77
  v_cvt_pk_bf16_f32 v69, v74, v75
  v_exp_f32 v78, v78
  v_exp_f32 v79, v79
  v_cvt_pk_bf16_f32 v70, v76, v77
  v_cvt_pk_bf16_f32 v71, v78, v79
  v_exp_f32_e64 v80, v80
  v_mfma_f32_32x32x16_bf16 v[96:111], v[150:153], v[134:137], v[48:63]
  v_exp_f32 v81, v81
  v_exp_f32 v82, v82
  ds_read_b64_tr_b16 v[162:163], v140 offset:1024
  v_exp_f32_e64 v83, v83
  v_cvt_pk_bf16_f32 v80, v80, v81
  v_exp_f32_e64 v84, v84
  v_mfma_f32_32x32x8_bf16 v[96:111], v[154:155], v[130:131], v[96:111]
  v_exp_f32_e64 v85, v85
  ds_read_b64_tr_b16 v[164:165], v140 offset:1152
  v_cvt_pk_bf16_f32 v81, v82, v83
  v_exp_f32 v86, v86
  v_exp_f32 v87, v87
  v_cvt_pk_bf16_f32 v82, v84, v85
  ds_read_b64_tr_b16 v[166:167], v140 offset:1280
  v_exp_f32 v88, v88
  s_waitcnt lgkmcnt(3)
  v_mfma_f32_32x32x16_bf16 v[0:15], v[112:115], v[64:67], 0
  v_exp_f32_e64 v89, v89
  v_cvt_pk_bf16_f32 v83, v86, v87
  v_exp_f32_e64 v90, v90
  ds_read_b64_tr_b16 v[168:169], v140 offset:1408
  v_exp_f32_e64 v91, v91
  v_cvt_pk_bf16_f32 v84, v88, v89
  v_mfma_f32_32x32x16_bf16 v[0:15], v[116:119], v[68:71], v[0:15]
  v_exp_f32 v92, v92
  v_exp_f32 v93, v93
  v_cvt_pk_bf16_f32 v85, v90, v91
  v_exp_f32 v94, v94
  v_exp_f32 v95, v95
  v_cvt_pk_bf16_f32 v86, v92, v93
  v_cvt_pk_bf16_f32 v87, v94, v95
  v_exp_f32_e64 v96, v96
  v_mfma_f32_32x32x16_bf16 v[64:79], v[156:159], v[124:127], 0
  v_exp_f32 v97, v97
  v_exp_f32 v98, v98
  v_exp_f32_e64 v99, v99
  v_cvt_pk_bf16_f32 v96, v96, v97
  v_exp_f32_e64 v100, v100
  v_mfma_f32_32x32x8_bf16 v[64:79], v[160:161], v[128:129], v[64:79]
  v_exp_f32_e64 v101, v101
  v_cvt_pk_bf16_f32 v97, v98, v99
  ds_read_b128 v[150:153], v138 offset:2048
  v_exp_f32 v102, v102
  v_exp_f32 v103, v103
  ds_read_b64 v[154:155], v139 offset:2048
  v_cvt_pk_bf16_f32 v98, v100, v101
  v_exp_f32_e64 v104, v104
  v_mfma_f32_32x32x16_bf16 v[0:15], v[172:175], v[80:83], v[0:15]
  v_exp_f32_e64 v105, v105
  v_cvt_pk_bf16_f32 v99, v102, v103
  v_exp_f32 v106, v106
  v_exp_f32 v107, v107
  v_cvt_pk_bf16_f32 v100, v104, v105
  v_mfma_f32_32x32x16_bf16 v[0:15], v[176:179], v[84:87], v[0:15]
  v_exp_f32 v108, v108
  v_exp_f32 v109, v109
  v_cvt_pk_bf16_f32 v101, v106, v107
  v_exp_f32 v110, v110
  v_exp_f32 v111, v111
  v_cvt_pk_bf16_f32 v102, v108, v109
  v_cvt_pk_bf16_f32 v103, v110, v111
  v_exp_f32_e64 v64, v64
  v_mfma_f32_32x32x16_bf16 v[80:95], v[156:159], v[134:137], 0
  v_exp_f32 v65, v65
  v_exp_f32 v66, v66
  ds_read_b64_tr_b16 v[112:113], v140 offset:1536
  v_exp_f32_e64 v67, v67
  v_cvt_pk_bf16_f32 v64, v64, v65
  v_exp_f32_e64 v68, v68
  v_mfma_f32_32x32x8_bf16 v[80:95], v[160:161], v[130:131], v[80:95]
  v_exp_f32_e64 v69, v69
  ds_read_b64_tr_b16 v[114:115], v140 offset:1664
  v_cvt_pk_bf16_f32 v65, v66, v67
  v_exp_f32 v70, v70
  v_exp_f32 v71, v71
  v_cvt_pk_bf16_f32 v66, v68, v69
  ds_read_b64_tr_b16 v[116:117], v140 offset:1792
  v_exp_f32_e64 v72, v72
  v_mfma_f32_32x32x16_bf16 v[16:31], v[172:175], v[96:99], 0
  v_exp_f32_e64 v73, v73
  v_cvt_pk_bf16_f32 v67, v70, v71
  v_exp_f32_e64 v74, v74
  ds_read_b64_tr_b16 v[118:119], v140 offset:1920
  v_exp_f32_e64 v75, v75
  v_cvt_pk_bf16_f32 v68, v72, v73
  v_mfma_f32_32x32x16_bf16 v[16:31], v[176:179], v[100:103], v[16:31]
  v_exp_f32 v76, v76
  v_exp_f32 v77, v77
  v_cvt_pk_bf16_f32 v69, v74, v75
  v_exp_f32 v78, v78
  v_exp_f32 v79, v79
  v_cvt_pk_bf16_f32 v70, v76, v77
  v_cvt_pk_bf16_f32 v71, v78, v79
  v_exp_f32_e64 v80, v80
  v_mfma_f32_32x32x16_bf16 v[96:111], v[144:147], v[124:127], 0
  v_exp_f32 v81, v81
  v_exp_f32 v82, v82
  v_exp_f32_e64 v83, v83
  v_cvt_pk_bf16_f32 v80, v80, v81
  v_exp_f32_e64 v84, v84
  v_mfma_f32_32x32x8_bf16 v[96:111], v[148:149], v[128:129], v[96:111]
  v_exp_f32_e64 v85, v85
  v_cvt_pk_bf16_f32 v81, v82, v83
  ds_read_b128 v[156:159], v138 offset:2560
  v_exp_f32 v86, v86
  v_exp_f32 v87, v87
  ds_read_b64 v[160:161], v139 offset:2560
  v_cvt_pk_bf16_f32 v82, v84, v85
  v_exp_f32 v88, v88
  s_waitcnt lgkmcnt(3)
  v_mfma_f32_32x32x16_bf16 v[0:15], v[162:165], v[64:67], v[0:15]
  v_exp_f32_e64 v89, v89
  v_cvt_pk_bf16_f32 v83, v86, v87
  v_exp_f32 v90, v90
  v_exp_f32 v91, v91
  v_cvt_pk_bf16_f32 v84, v88, v89
  v_mfma_f32_32x32x16_bf16 v[0:15], v[166:169], v[68:71], v[0:15]
  v_exp_f32 v92, v92
  v_exp_f32 v93, v93
  v_cvt_pk_bf16_f32 v85, v90, v91
  v_exp_f32 v94, v94
  v_exp_f32 v95, v95
  v_cvt_pk_bf16_f32 v86, v92, v93
  v_cvt_pk_bf16_f32 v87, v94, v95
  v_exp_f32_e64 v96, v96
  v_mfma_f32_32x32x16_bf16 v[64:79], v[144:147], v[134:137], 0
  v_exp_f32 v97, v97
  v_exp_f32 v98, v98
  ds_read_b64_tr_b16 v[172:173], v140 offset:2048
  v_exp_f32_e64 v99, v99
  v_cvt_pk_bf16_f32 v96, v96, v97
  v_exp_f32_e64 v100, v100
  v_mfma_f32_32x32x8_bf16 v[64:79], v[148:149], v[130:131], v[64:79]
  v_exp_f32_e64 v101, v101
  ds_read_b64_tr_b16 v[174:175], v140 offset:2176
  v_cvt_pk_bf16_f32 v97, v98, v99
  v_exp_f32 v102, v102
  v_exp_f32 v103, v103
  v_cvt_pk_bf16_f32 v98, v100, v101
  ds_read_b64_tr_b16 v[176:177], v140 offset:2304
  v_exp_f32_e64 v104, v104
  v_mfma_f32_32x32x16_bf16 v[16:31], v[162:165], v[80:83], v[16:31]
  v_exp_f32_e64 v105, v105
  v_cvt_pk_bf16_f32 v99, v102, v103
  v_exp_f32_e64 v106, v106
  ds_read_b64_tr_b16 v[178:179], v140 offset:2432
  v_exp_f32_e64 v107, v107
  v_cvt_pk_bf16_f32 v100, v104, v105
  v_mfma_f32_32x32x16_bf16 v[16:31], v[166:169], v[84:87], v[16:31]
  v_exp_f32 v108, v108
  v_exp_f32 v109, v109
  v_cvt_pk_bf16_f32 v101, v106, v107
  v_exp_f32 v110, v110
  v_exp_f32 v111, v111
  v_cvt_pk_bf16_f32 v102, v108, v109
  v_cvt_pk_bf16_f32 v103, v110, v111
  v_exp_f32_e64 v64, v64
  v_mfma_f32_32x32x16_bf16 v[80:95], v[150:153], v[124:127], 0
  v_exp_f32 v65, v65
  v_exp_f32 v66, v66
  v_exp_f32_e64 v67, v67
  v_cvt_pk_bf16_f32 v64, v64, v65
  v_exp_f32_e64 v68, v68
  v_mfma_f32_32x32x8_bf16 v[80:95], v[154:155], v[128:129], v[80:95]
  v_exp_f32_e64 v69, v69
  v_cvt_pk_bf16_f32 v65, v66, v67
  ds_read_b128 v[144:147], v138 offset:3072
  v_exp_f32 v70, v70
  v_exp_f32 v71, v71
  ds_read_b64 v[148:149], v139 offset:3072
  v_cvt_pk_bf16_f32 v66, v68, v69
  v_exp_f32_e64 v72, v72
  v_mfma_f32_32x32x16_bf16 v[0:15], v[112:115], v[96:99], v[0:15]
  v_exp_f32_e64 v73, v73
  v_cvt_pk_bf16_f32 v67, v70, v71
  v_exp_f32 v74, v74
  v_exp_f32 v75, v75
  v_cvt_pk_bf16_f32 v68, v72, v73
  s_waitcnt lgkmcnt(2)
  v_mfma_f32_32x32x16_bf16 v[0:15], v[116:119], v[100:103], v[0:15]
  v_exp_f32 v76, v76
  v_exp_f32_e64 v77, v77
  v_cvt_pk_bf16_f32 v69, v74, v75
  v_exp_f32 v78, v78
  v_exp_f32 v79, v79
  v_cvt_pk_bf16_f32 v70, v76, v77
  v_cvt_pk_bf16_f32 v71, v78, v79
  v_exp_f32_e64 v80, v80
  v_mfma_f32_32x32x16_bf16 v[96:111], v[150:153], v[134:137], 0
  v_exp_f32 v81, v81
  v_exp_f32 v82, v82
  ds_read_b64_tr_b16 v[162:163], v140 offset:2560
  v_exp_f32_e64 v83, v83
  v_cvt_pk_bf16_f32 v80, v80, v81
  v_exp_f32_e64 v84, v84
  v_mfma_f32_32x32x8_bf16 v[96:111], v[154:155], v[130:131], v[96:111]
  v_exp_f32_e64 v85, v85
  ds_read_b64_tr_b16 v[164:165], v140 offset:2688
  v_cvt_pk_bf16_f32 v81, v82, v83
  v_exp_f32 v86, v86
  v_exp_f32 v87, v87
  v_cvt_pk_bf16_f32 v82, v84, v85
  ds_read_b64_tr_b16 v[166:167], v140 offset:2816
  v_exp_f32_e64 v88, v88
  v_mfma_f32_32x32x16_bf16 v[16:31], v[112:115], v[64:67], v[16:31]
  v_exp_f32_e64 v89, v89
  v_cvt_pk_bf16_f32 v83, v86, v87
  v_exp_f32_e64 v90, v90
  ds_read_b64_tr_b16 v[168:169], v140 offset:2944
  v_exp_f32_e64 v91, v91
  v_cvt_pk_bf16_f32 v84, v88, v89
  v_mfma_f32_32x32x16_bf16 v[16:31], v[116:119], v[68:71], v[16:31]
  v_exp_f32 v92, v92
  v_exp_f32 v93, v93
  v_cvt_pk_bf16_f32 v85, v90, v91
  v_exp_f32 v94, v94
  v_exp_f32 v95, v95
  v_cvt_pk_bf16_f32 v86, v92, v93
  v_cvt_pk_bf16_f32 v87, v94, v95
  v_exp_f32_e64 v96, v96
  v_mfma_f32_32x32x16_bf16 v[64:79], v[156:159], v[124:127], 0
  v_exp_f32 v97, v97
  v_exp_f32 v98, v98
  v_exp_f32_e64 v99, v99
  v_cvt_pk_bf16_f32 v96, v96, v97
  v_exp_f32_e64 v100, v100
  v_mfma_f32_32x32x8_bf16 v[64:79], v[160:161], v[128:129], v[64:79]
  v_exp_f32_e64 v101, v101
  v_cvt_pk_bf16_f32 v97, v98, v99
  ds_read_b128 v[150:153], v138 offset:3584
  v_exp_f32 v102, v102
  v_exp_f32 v103, v103
  ds_read_b64 v[154:155], v139 offset:3584
  v_cvt_pk_bf16_f32 v98, v100, v101
  v_exp_f32_e64 v104, v104
  v_mfma_f32_32x32x16_bf16 v[0:15], v[172:175], v[80:83], v[0:15]
  v_exp_f32_e64 v105, v105
  v_cvt_pk_bf16_f32 v99, v102, v103
  v_exp_f32 v106, v106
  v_exp_f32 v107, v107
  v_cvt_pk_bf16_f32 v100, v104, v105
  v_mfma_f32_32x32x16_bf16 v[0:15], v[176:179], v[84:87], v[0:15]
  v_exp_f32 v108, v108
  v_exp_f32 v109, v109
  v_cvt_pk_bf16_f32 v101, v106, v107
  v_exp_f32 v110, v110
  v_exp_f32 v111, v111
  v_cvt_pk_bf16_f32 v102, v108, v109
  v_cvt_pk_bf16_f32 v103, v110, v111
  v_exp_f32_e64 v64, v64
  v_mfma_f32_32x32x16_bf16 v[80:95], v[156:159], v[134:137], 0
  v_exp_f32 v65, v65
  v_exp_f32 v66, v66
  ds_read_b64_tr_b16 v[112:113], v140 offset:3072
  v_exp_f32_e64 v67, v67
  v_cvt_pk_bf16_f32 v64, v64, v65
  v_exp_f32_e64 v68, v68
  v_mfma_f32_32x32x8_bf16 v[80:95], v[160:161], v[130:131], v[80:95]
  v_exp_f32_e64 v69, v69
  ds_read_b64_tr_b16 v[114:115], v140 offset:3200
  v_cvt_pk_bf16_f32 v65, v66, v67
  v_exp_f32 v70, v70
  v_exp_f32 v71, v71
  v_cvt_pk_bf16_f32 v66, v68, v69
  ds_read_b64_tr_b16 v[116:117], v140 offset:3328
  v_exp_f32_e64 v72, v72
  v_mfma_f32_32x32x16_bf16 v[16:31], v[172:175], v[96:99], v[16:31]
  v_exp_f32_e64 v73, v73
  v_cvt_pk_bf16_f32 v67, v70, v71
  v_exp_f32_e64 v74, v74
  ds_read_b64_tr_b16 v[118:119], v140 offset:3456
  v_exp_f32_e64 v75, v75
  v_cvt_pk_bf16_f32 v68, v72, v73
  v_mfma_f32_32x32x16_bf16 v[16:31], v[176:179], v[100:103], v[16:31]
  v_exp_f32 v76, v76
  v_exp_f32 v77, v77
  v_cvt_pk_bf16_f32 v69, v74, v75
  v_exp_f32 v78, v78
  v_exp_f32 v79, v79
  v_cvt_pk_bf16_f32 v70, v76, v77
  v_cvt_pk_bf16_f32 v71, v78, v79
  v_exp_f32 v80, v80
  s_waitcnt lgkmcnt(4)
  v_mfma_f32_32x32x16_bf16 v[96:111], v[144:147], v[124:127], 0
  v_exp_f32 v81, v81
  v_exp_f32 v82, v82
  v_exp_f32_e64 v83, v83
  v_cvt_pk_bf16_f32 v80, v80, v81
  v_exp_f32_e64 v84, v84
  v_mfma_f32_32x32x8_bf16 v[96:111], v[148:149], v[128:129], v[96:111]
  v_exp_f32_e64 v85, v85
  v_cvt_pk_bf16_f32 v81, v82, v83
  ds_read_b128 v[156:159], v138 offset:4096
  v_exp_f32 v86, v86
  v_exp_f32 v87, v87
  ds_read_b64 v[160:161], v139 offset:4096
  v_cvt_pk_bf16_f32 v82, v84, v85
  v_exp_f32_e64 v88, v88
  v_mfma_f32_32x32x16_bf16 v[0:15], v[162:165], v[64:67], v[0:15]
  v_exp_f32_e64 v89, v89
  v_cvt_pk_bf16_f32 v83, v86, v87
  v_exp_f32 v90, v90
  v_exp_f32 v91, v91
  v_cvt_pk_bf16_f32 v84, v88, v89
  v_mfma_f32_32x32x16_bf16 v[0:15], v[166:169], v[68:71], v[0:15]
  v_exp_f32 v92, v92
  v_exp_f32 v93, v93
  v_cvt_pk_bf16_f32 v85, v90, v91
  v_exp_f32 v94, v94
  v_exp_f32 v95, v95
  v_cvt_pk_bf16_f32 v86, v92, v93
  v_cvt_pk_bf16_f32 v87, v94, v95
  v_exp_f32_e64 v96, v96
  v_mfma_f32_32x32x16_bf16 v[64:79], v[144:147], v[134:137], 0
  v_exp_f32 v97, v97
  v_exp_f32 v98, v98
  ds_read_b64_tr_b16 v[172:173], v140 offset:3584
  v_exp_f32_e64 v99, v99
  v_cvt_pk_bf16_f32 v96, v96, v97
  v_exp_f32_e64 v100, v100
  v_mfma_f32_32x32x8_bf16 v[64:79], v[148:149], v[130:131], v[64:79]
  v_exp_f32_e64 v101, v101
  ds_read_b64_tr_b16 v[174:175], v140 offset:3712
  v_cvt_pk_bf16_f32 v97, v98, v99
  v_exp_f32 v102, v102
  v_exp_f32 v103, v103
  v_cvt_pk_bf16_f32 v98, v100, v101
  ds_read_b64_tr_b16 v[176:177], v140 offset:3840
  v_exp_f32_e64 v104, v104
  v_mfma_f32_32x32x16_bf16 v[16:31], v[162:165], v[80:83], v[16:31]
  v_exp_f32_e64 v105, v105
  v_cvt_pk_bf16_f32 v99, v102, v103
  v_exp_f32_e64 v106, v106
  ds_read_b64_tr_b16 v[178:179], v140 offset:3968
  v_exp_f32_e64 v107, v107
  v_cvt_pk_bf16_f32 v100, v104, v105
  v_mfma_f32_32x32x16_bf16 v[16:31], v[166:169], v[84:87], v[16:31]
  v_exp_f32 v108, v108
  v_exp_f32 v109, v109
  v_cvt_pk_bf16_f32 v101, v106, v107
  v_exp_f32 v110, v110
  v_exp_f32 v111, v111
  v_cvt_pk_bf16_f32 v102, v108, v109
  v_cvt_pk_bf16_f32 v103, v110, v111
  v_exp_f32_e64 v64, v64
  v_mfma_f32_32x32x16_bf16 v[80:95], v[150:153], v[124:127], 0
  v_exp_f32 v65, v65
  v_exp_f32 v66, v66
  v_exp_f32_e64 v67, v67
  v_cvt_pk_bf16_f32 v64, v64, v65
  v_exp_f32_e64 v68, v68
  v_mfma_f32_32x32x8_bf16 v[80:95], v[154:155], v[128:129], v[80:95]
  v_exp_f32_e64 v69, v69
  v_cvt_pk_bf16_f32 v65, v66, v67
  ds_read_b128 v[144:147], v138 offset:4608
  v_exp_f32 v70, v70
  v_exp_f32 v71, v71
  ds_read_b64 v[148:149], v139 offset:4608
  v_cvt_pk_bf16_f32 v66, v68, v69
  v_exp_f32 v72, v72
  s_waitcnt lgkmcnt(3)
  v_mfma_f32_32x32x16_bf16 v[0:15], v[112:115], v[96:99], v[0:15]
  v_exp_f32_e64 v73, v73
  v_cvt_pk_bf16_f32 v67, v70, v71
  v_exp_f32 v74, v74
  v_exp_f32 v75, v75
  v_cvt_pk_bf16_f32 v68, v72, v73
  v_mfma_f32_32x32x16_bf16 v[0:15], v[116:119], v[100:103], v[0:15]
  v_exp_f32 v76, v76
  v_exp_f32 v77, v77
  v_cvt_pk_bf16_f32 v69, v74, v75
  v_exp_f32 v78, v78
  v_exp_f32 v79, v79
  v_cvt_pk_bf16_f32 v70, v76, v77
  v_cvt_pk_bf16_f32 v71, v78, v79
  v_exp_f32_e64 v80, v80
  v_mfma_f32_32x32x16_bf16 v[96:111], v[150:153], v[134:137], 0
  v_exp_f32 v81, v81
  v_exp_f32 v82, v82
  ds_read_b64_tr_b16 v[162:163], v140 offset:4096
  v_exp_f32_e64 v83, v83
  v_cvt_pk_bf16_f32 v80, v80, v81
  v_exp_f32_e64 v84, v84
  v_mfma_f32_32x32x8_bf16 v[96:111], v[154:155], v[130:131], v[96:111]
  v_exp_f32_e64 v85, v85
  ds_read_b64_tr_b16 v[164:165], v140 offset:4224
  v_cvt_pk_bf16_f32 v81, v82, v83
  v_exp_f32 v86, v86
  v_exp_f32 v87, v87
  v_cvt_pk_bf16_f32 v82, v84, v85
  ds_read_b64_tr_b16 v[166:167], v140 offset:4352
  v_exp_f32_e64 v88, v88
  v_mfma_f32_32x32x16_bf16 v[16:31], v[112:115], v[64:67], v[16:31]
  v_exp_f32_e64 v89, v89
  v_cvt_pk_bf16_f32 v83, v86, v87
  v_exp_f32_e64 v90, v90
  ds_read_b64_tr_b16 v[168:169], v140 offset:4480
  v_exp_f32_e64 v91, v91
  v_cvt_pk_bf16_f32 v84, v88, v89
  v_mfma_f32_32x32x16_bf16 v[16:31], v[116:119], v[68:71], v[16:31]
  v_exp_f32 v92, v92
  v_exp_f32 v93, v93
  v_cvt_pk_bf16_f32 v85, v90, v91
  v_exp_f32 v94, v94
  v_exp_f32 v95, v95
  v_cvt_pk_bf16_f32 v86, v92, v93
  v_cvt_pk_bf16_f32 v87, v94, v95
  v_exp_f32_e64 v96, v96
  v_mfma_f32_32x32x16_bf16 v[64:79], v[156:159], v[124:127], v[32:47]
  v_exp_f32 v97, v97
  v_exp_f32 v98, v98
  v_exp_f32_e64 v99, v99
  v_cvt_pk_bf16_f32 v96, v96, v97
  v_exp_f32_e64 v100, v100
  v_mfma_f32_32x32x8_bf16 v[64:79], v[160:161], v[128:129], v[64:79]
  v_exp_f32_e64 v101, v101
  v_cvt_pk_bf16_f32 v97, v98, v99
  v_exp_f32 v102, v102
  v_exp_f32 v103, v103
  v_cvt_pk_bf16_f32 v98, v100, v101
  v_exp_f32_e64 v104, v104
  v_mfma_f32_32x32x16_bf16 v[0:15], v[172:175], v[80:83], v[0:15]
  v_exp_f32_e64 v105, v105
  v_cvt_pk_bf16_f32 v99, v102, v103
  v_exp_f32 v106, v106
  v_exp_f32 v107, v107
  v_cvt_pk_bf16_f32 v100, v104, v105
  s_waitcnt lgkmcnt(0)
  v_mfma_f32_32x32x16_bf16 v[0:15], v[176:179], v[84:87], v[0:15]
  v_exp_f32 v108, v108
  v_exp_f32_e64 v109, v109
  v_cvt_pk_bf16_f32 v101, v106, v107
  v_exp_f32 v110, v110
  v_exp_f32 v111, v111
  v_cvt_pk_bf16_f32 v102, v108, v109
  v_cvt_pk_bf16_f32 v103, v110, v111
  v_exp_f32_e64 v64, v64
  v_mfma_f32_32x32x16_bf16 v[80:95], v[156:159], v[134:137], 0
  v_exp_f32 v65, v65
  v_exp_f32 v66, v66
  ds_read_b64_tr_b16 v[112:113], v140 offset:4608
  v_exp_f32_e64 v67, v67
  v_cvt_pk_bf16_f32 v64, v64, v65
  v_exp_f32_e64 v68, v68
  v_mfma_f32_32x32x8_bf16 v[80:95], v[160:161], v[130:131], v[80:95]
  v_exp_f32_e64 v69, v69
  ds_read_b64_tr_b16 v[114:115], v140 offset:4736
  v_cvt_pk_bf16_f32 v65, v66, v67
  v_exp_f32 v70, v70
  v_exp_f32 v71, v71
  v_cvt_pk_bf16_f32 v66, v68, v69
  ds_read_b64_tr_b16 v[116:117], v140 offset:4864
  v_exp_f32_e64 v72, v72
  v_mfma_f32_32x32x16_bf16 v[16:31], v[172:175], v[96:99], v[16:31]
  v_exp_f32_e64 v73, v73
  v_cvt_pk_bf16_f32 v67, v70, v71
  v_exp_f32_e64 v74, v74
  ds_read_b64_tr_b16 v[118:119], v140 offset:4992
  v_exp_f32_e64 v75, v75
  v_cvt_pk_bf16_f32 v68, v72, v73
  v_mfma_f32_32x32x16_bf16 v[16:31], v[176:179], v[100:103], v[16:31]
  v_exp_f32 v76, v76
  v_exp_f32 v77, v77
  v_cvt_pk_bf16_f32 v69, v74, v75
  v_exp_f32 v78, v78
  v_exp_f32 v79, v79
  v_cvt_pk_bf16_f32 v70, v76, v77
  v_cvt_pk_bf16_f32 v71, v78, v79
  v_exp_f32_e64 v80, v80
  v_mfma_f32_32x32x16_bf16 v[96:111], v[144:147], v[134:137], v[32:47]
  v_exp_f32 v81, v81
  v_exp_f32 v82, v82
  v_exp_f32_e64 v83, v83
  v_cvt_pk_bf16_f32 v80, v80, v81
  v_exp_f32_e64 v84, v84
  v_mfma_f32_32x32x8_bf16 v[96:111], v[148:149], v[130:131], v[96:111]
  v_exp_f32_e64 v85, v85
  v_cvt_pk_bf16_f32 v81, v82, v83
  v_exp_f32 v86, v86
  v_exp_f32 v87, v87
  v_cvt_pk_bf16_f32 v82, v84, v85
  v_exp_f32_e64 v88, v88
  v_mfma_f32_32x32x16_bf16 v[0:15], v[162:165], v[64:67], v[0:15]
  v_exp_f32_e64 v89, v89
  v_cvt_pk_bf16_f32 v83, v86, v87
  v_exp_f32 v90, v90
  v_exp_f32 v91, v91
  v_cvt_pk_bf16_f32 v84, v88, v89
  v_mfma_f32_32x32x16_bf16 v[0:15], v[166:169], v[68:71], v[0:15]
  v_exp_f32 v92, v92
  v_exp_f32 v93, v93
  v_cvt_pk_bf16_f32 v85, v90, v91
  v_exp_f32 v94, v94
  v_exp_f32 v95, v95
  v_cvt_pk_bf16_f32 v86, v92, v93
  v_cvt_pk_bf16_f32 v87, v94, v95
  v_exp_f32 v96, v96
  v_exp_f32 v97, v97
  v_exp_f32 v98, v98
  v_exp_f32 v99, v99
  v_cvt_pk_bf16_f32 v96, v96, v97
  v_exp_f32 v100, v100
  v_exp_f32 v101, v101
  v_cvt_pk_bf16_f32 v97, v98, v99
  v_exp_f32 v102, v102
  v_exp_f32 v103, v103
  v_cvt_pk_bf16_f32 v98, v100, v101
  v_exp_f32_e64 v104, v104
  v_mfma_f32_32x32x16_bf16 v[16:31], v[162:165], v[80:83], v[16:31]
  v_exp_f32_e64 v105, v105
  v_cvt_pk_bf16_f32 v99, v102, v103
  v_exp_f32 v106, v106
  v_exp_f32 v107, v107
  v_cvt_pk_bf16_f32 v100, v104, v105
  v_mfma_f32_32x32x16_bf16 v[16:31], v[166:169], v[84:87], v[16:31]
  v_exp_f32 v108, v108
  v_exp_f32 v109, v109
  v_cvt_pk_bf16_f32 v101, v106, v107
  v_exp_f32 v110, v110
  v_exp_f32 v111, v111
  v_cvt_pk_bf16_f32 v102, v108, v109
  v_cvt_pk_bf16_f32 v103, v110, v111
  s_waitcnt lgkmcnt(0)
  v_mfma_f32_32x32x16_bf16 v[16:31], v[112:115], v[96:99], v[16:31]
  v_mfma_f32_32x32x16_bf16 v[16:31], v[116:119], v[100:103], v[16:31]
  s_nop 15
  s_branch L_back
  s_endpgm
.section .rodata,"a"
.p2align 6
.amdhsa_kernel parallel_sum__sliding_block__mixer_channel_mlp__prompt_kernel
  .amdhsa_next_free_vgpr 512
  .amdhsa_next_free_sgpr 102
  .amdhsa_accum_offset 256
  .amdhsa_group_segment_fixed_size 0
  .amdhsa_kernarg_size 88
  .amdhsa_user_sgpr_count 2
  .amdhsa_user_sgpr_kernarg_segment_ptr 1
  .amdhsa_system_sgpr_workgroup_id_x 1
.end_amdhsa_kernel
```
